```python
import torch

def _softmax(x, axis=-1):
    return torch.softmax(x, dim=axis)

def _gelu(x):
    return torch.nn.functional.gelu(x, approximate='tanh')

def _silu(x):
    return torch.nn.functional.silu(x)

def _sigmoid(x):
    return torch.sigmoid(x)

def _layernorm(x, axis=-1, eps=1e-05):
    m = x.mean(dim=axis, keepdim=True)
    v = x.var(dim=axis, keepdim=True, unbiased=False)
    return (x - m) / torch.sqrt(v + eps)

def _scatter_add(tgt, idx, src, axis=0):
    return tgt.clone().index_add_(axis, idx, src)

def _segment_sum(src, seg, n):
    out = torch.zeros((n,) + src.shape[1:], dtype=src.dtype)
    return out.index_add_(0, seg, src)

def _pad(x, pw):
    flat = tuple((v for pair in reversed(pw) for v in pair))
    return torch.nn.functional.pad(x, flat)
kernel_name = 'gather_scatter__tensor_product_equiv_equiformer__graph'

def setup_inputs():

    _w = lambda a: (lambda t: t.to(torch.bfloat16) if t.is_floating_point() else t)(torch.as_tensor(a))
    N, deg, C, De = (10000, 64, 64, max(16, 1))
    E = N * deg
    src = (lambda lo, hi, *s: torch.randint(lo, hi, s))(0, N, E).to(torch.int64)
    dst = (lambda lo, hi, *s: torch.randint(lo, hi, s))(0, N, E).to(torch.int64)
    rvec = (lambda *s: torch.randn(*s, dtype=torch.bfloat16) * 0.05)(E, 3).to(float)
    rn = (torch.linalg.norm(rvec, dim=-1, keepdim=True) + 1e-06).to(float)
    rhat = (rvec / rn).to(float)
    eps = torch.zeros((3, 3, 3), dtype=float)
    eps[0, 1, 2] = eps[1, 2, 0] = eps[2, 0, 1] = 1.0
    eps[0, 2, 1] = eps[2, 1, 0] = eps[1, 0, 2] = -1.0
    return {'x': _w((lambda *s: torch.randn(*s, dtype=torch.bfloat16) * 0.2)(N, 4 * C).to(float)), 'rhat': _w(rhat), 'e_attr': _w((lambda *s: torch.randn(*s, dtype=torch.bfloat16) * 0.2)(E, De).to(float)), 'src': _w(src), 'dst': _w(dst), 'w_rad': _w((lambda *s: torch.randn(*s, dtype=torch.bfloat16) * 0.2)(De, 5 * C).to(float)), 'w_si0': _w((lambda *s: torch.randn(*s, dtype=torch.bfloat16) * 0.2)(2 * C, C).to(float)), 'w_si1': _w((lambda *s: torch.randn(*s, dtype=torch.bfloat16) * 0.05)(3 * C, C).to(float)), 'cg_eps': _w(eps)}

def reference(x, rhat, e_attr, src, dst, w_rad, w_si0, w_si1, cg_eps):
    N = x.shape[0]
    C = w_si0.shape[1]
    E = rhat.shape[0]
    x0 = x[:, :C].clone()
    x1 = x[:, C:].reshape(N, 3, C)
    R = (e_attr @ w_rad).reshape(E, 5, C)
    f0 = x0[src]
    f1 = x1[src]
    Y1 = rhat
    p00_0 = f0 * R[:, 0, :]
    p11_0 = torch.einsum('ejc,ej->ec', f1, Y1) * R[:, 1, :]
    p01_1 = torch.einsum('ec,ej->ejc', f0, Y1) * R[:, 2, :][:, None, :]
    p10_1 = f1 * R[:, 3, :][:, None, :]
    p11_1 = torch.einsum('ijk,ekc,ej->eic', cg_eps, f1, Y1) * R[:, 4, :][:, None, :]
    m0 = torch.concatenate([p00_0, p11_0], axis=-1) @ w_si0
    m1 = torch.einsum('ejp,pc->ejc', torch.concatenate([p01_1, p10_1, p11_1], axis=-1), w_si1)
    agg0 = _segment_sum(m0, dst, N)
    agg1 = _segment_sum(m1.reshape(E, 3 * C), dst, N).reshape(N, 3, C)
    gate = _sigmoid(agg0)
    out1 = agg1 * gate[:, None, :]
    return torch.concatenate([agg0, out1.reshape(N, 3 * C)], axis=-1)
```

```asm
; @launch kernel=k1_kernel grid=(262,1,1) block=(640,1,1) lds=33280
; @launch kernel=k2_kernel grid=(250,1,1) block=(512,1,1) lds=163840
.amdgcn_target "amdgcn-amd-amdhsa--gfx950"
.text
.globl k1_kernel
.p2align 8
.type k1_kernel,@function
k1_kernel:
    s_cmp_ge_u32 s2, 262
    s_cbranch_scc1 k1_end
    s_load_dwordx2 s[16:17], s[0:1], 88
    s_mov_b32 s18, 268435456
    s_mov_b32 s19, 0x00020000
    s_cmp_ge_u32 s2, 256
    s_cbranch_scc1 k1_w
    s_load_dwordx2 s[4:5], s[0:1], 32
    s_mov_b32 s6, 2560000
    s_mov_b32 s7, 0x00020000
    s_load_dwordx2 s[8:9], s[0:1], 24
    s_mov_b32 s10, 2560000
    s_mov_b32 s11, 0x00020000
    s_load_dwordx2 s[12:13], s[0:1], 8
    s_mov_b32 s14, 3840000
    s_mov_b32 s15, 0x00020000
    v_lshlrev_b32 v1, 2, v0
    v_mov_b32 v2, 0
    ds_write_b32 v1, v2 offset:30720
    s_mul_i32 s20, s2, 10000
    s_mul_i32 s21, s2, 15000
    v_lshlrev_b32 v2, 4, v0
    v_add_u32 v2, s20, v2
    v_mul_u32_u24 v3, 24, v0
    v_add_u32 v3, s21, v3
    v_cmp_gt_u32 vcc, 625, v0
    s_and_saveexec_b64 s[22:23], vcc
    s_waitcnt lgkmcnt(0)
    buffer_load_dwordx4 v[4:7], v2, s[4:7], 0 offen
    s_barrier
    buffer_load_dwordx4 v[8:11], v2, s[8:11], 0 offen
    buffer_load_dwordx4 v[12:15], v3, s[12:15], 0 offen
    buffer_load_dwordx2 v[16:17], v3, s[12:15], 0 offen offset:16
    v_lshlrev_b32 v18, 3, v2
    v_mov_b32 v19, 1
    s_mov_b32 s24, 0x05040100
    s_mov_b32 s25, 0x05040302
    s_mov_b32 s28, 429497
    s_movk_i32 s29, 625
    s_waitcnt vmcnt(3)
    v_mul_u32_u24 v32, 0xcccd, v4
    v_lshrrev_b32 v32, 18, v32
    v_bfe_u32 v34, v32, 3, 3
    v_lshrrev_b32 v35, 6, v32
    v_lshlrev_b32 v35, 2, v35
    v_lshl_or_b32 v20, v34, 7, v35
    ds_add_rtn_u32 v28, v20, v19 offset:30720
    v_mad_i32_i24 v33, v32, -5, v4
    v_and_b32 v34, 7, v32
    v_lshl_or_b32 v33, v34, 3, v33
    v_add_u32 v34, 0, v18
    v_lshl_or_b32 v24, v33, 26, v34
    v_mul_u32_u24 v32, 0xcccd, v5
    v_lshrrev_b32 v32, 18, v32
    v_bfe_u32 v34, v32, 3, 3
    v_lshrrev_b32 v35, 6, v32
    v_lshlrev_b32 v35, 2, v35
    v_lshl_or_b32 v21, v34, 7, v35
    ds_add_rtn_u32 v29, v21, v19 offset:30720
    v_mad_i32_i24 v33, v32, -5, v5
    v_and_b32 v34, 7, v32
    v_lshl_or_b32 v33, v34, 3, v33
    v_add_u32 v34, 32, v18
    v_lshl_or_b32 v25, v33, 26, v34
    v_mul_u32_u24 v32, 0xcccd, v6
    v_lshrrev_b32 v32, 18, v32
    v_bfe_u32 v34, v32, 3, 3
    v_lshrrev_b32 v35, 6, v32
    v_lshlrev_b32 v35, 2, v35
    v_lshl_or_b32 v22, v34, 7, v35
    ds_add_rtn_u32 v30, v22, v19 offset:30720
    v_mad_i32_i24 v33, v32, -5, v6
    v_and_b32 v34, 7, v32
    v_lshl_or_b32 v33, v34, 3, v33
    v_add_u32 v34, 64, v18
    v_lshl_or_b32 v26, v33, 26, v34
    v_mul_u32_u24 v32, 0xcccd, v7
    v_lshrrev_b32 v32, 18, v32
    v_bfe_u32 v34, v32, 3, 3
    v_lshrrev_b32 v35, 6, v32
    v_lshlrev_b32 v35, 2, v35
    v_lshl_or_b32 v23, v34, 7, v35
    ds_add_rtn_u32 v31, v23, v19 offset:30720
    v_mad_i32_i24 v33, v32, -5, v7
    v_and_b32 v34, 7, v32
    v_lshl_or_b32 v33, v34, 3, v33
    v_add_u32 v34, 96, v18
    v_lshl_or_b32 v27, v33, 26, v34
    s_mov_b64 s[26:27], exec
    s_mov_b64 exec, -1
    v_and_b32 v1, 63, v0
    v_lshlrev_b32 v1, 4, v1
    s_waitcnt lgkmcnt(0)
    s_barrier
    ds_read_b128 v[4:7], v1 offset:30720
    s_waitcnt lgkmcnt(0)
    v_add_u32 v48, v4, v5
    v_add_u32 v49, v6, v7
    v_add_u32 v48, v48, v49
    v_mov_b32 v49, v48
    s_nop 1
    v_add_u32_dpp v49, v49, v49 row_shr:1 row_mask:0xf bank_mask:0xf
    s_nop 1
    v_add_u32_dpp v49, v49, v49 row_shr:2 row_mask:0xf bank_mask:0xf
    s_nop 1
    v_add_u32_dpp v49, v49, v49 row_shr:4 row_mask:0xf bank_mask:0xf
    s_nop 1
    v_add_u32_dpp v49, v49, v49 row_shr:8 row_mask:0xf bank_mask:0xf
    s_nop 1
    v_add_u32_dpp v49, v49, v49 row_bcast:15 row_mask:0xa bank_mask:0xf
    s_nop 1
    v_add_u32_dpp v49, v49, v49 row_bcast:31 row_mask:0xc bank_mask:0xf
    v_sub_u32 v52, v49, v48
    v_add_u32 v53, v52, v4
    v_add_u32 v54, v53, v5
    v_add_u32 v55, v54, v6
    ds_write_b128 v1, v[52:55] offset:31744
    s_mov_b64 exec, s[26:27]
    ds_read_b32 v44, v20 offset:31744
    ds_read_b32 v45, v21 offset:31744
    ds_read_b32 v46, v22 offset:31744
    ds_read_b32 v47, v23 offset:31744
    s_waitcnt vmcnt(0)
    v_perm_b32 v40, v8, v13, s24
    v_alignbit_b32 v37, v14, v13, 16
    v_perm_b32 v41, v9, v14, s25
    v_perm_b32 v42, v10, v16, s24
    v_alignbit_b32 v39, v17, v16, 16
    v_perm_b32 v43, v11, v17, s25
    s_waitcnt lgkmcnt(3)
    v_add_u32 v44, v44, v28
    v_mul_u32_u24 v44, 12, v44
    ds_write2_b32 v44, v12, v40 offset0:0 offset1:1
    ds_write_b32 v44, v24 offset:8
    s_waitcnt lgkmcnt(4)
    v_add_u32 v45, v45, v29
    v_mul_u32_u24 v45, 12, v45
    ds_write2_b32 v45, v37, v41 offset0:0 offset1:1
    ds_write_b32 v45, v25 offset:8
    s_waitcnt lgkmcnt(5)
    v_add_u32 v46, v46, v30
    v_mul_u32_u24 v46, 12, v46
    ds_write2_b32 v46, v15, v42 offset0:0 offset1:1
    ds_write_b32 v46, v26 offset:8
    s_waitcnt lgkmcnt(6)
    v_add_u32 v47, v47, v31
    v_mul_u32_u24 v47, 12, v47
    ds_write2_b32 v47, v39, v43 offset0:0 offset1:1
    ds_write_b32 v47, v27 offset:8
    s_mov_b64 exec, -1
    v_cmp_gt_u32 vcc, 64, v0
    s_cbranch_vccz k1_notab
    v_lshl_or_b32 v4, v4, 16, v52
    v_lshl_or_b32 v5, v5, 16, v53
    v_lshl_or_b32 v6, v6, 16, v54
    v_lshl_or_b32 v7, v7, 16, v55
    s_lshl_b32 s20, s2, 10
    s_add_u32 s20, s20, 8388608
    v_add_u32 v8, s20, v1
    buffer_store_dwordx4 v[4:7], v8, s[16:19], 0 offen sc1
k1_notab:
    v_lshlrev_b32 v1, 4, v0
    s_mul_i32 s20, s2, 30080
    v_add_u32 v2, s20, v1
    v_add_u32 v3, 10240, v2
    v_add_u32 v16, 20480, v2
    v_cmp_gt_u32 vcc, 595, v0
    s_waitcnt lgkmcnt(0)
    s_barrier
    ds_read_b128 v[20:23], v1
    ds_read_b128 v[24:27], v1 offset:10240
    ds_read_b128 v[28:31], v1 offset:20480
    s_waitcnt lgkmcnt(2)
    buffer_store_dwordx4 v[20:23], v2, s[16:19], 0 offen sc1
    s_waitcnt lgkmcnt(1)
    buffer_store_dwordx4 v[24:27], v3, s[16:19], 0 offen sc1
    s_and_b64 exec, exec, vcc
    s_waitcnt lgkmcnt(0)
    buffer_store_dwordx4 v[28:31], v16, s[16:19], 0 offen sc1
    s_endpgm
k1_w:
    s_cmp_ge_u32 s2, 260
    s_cbranch_scc1 k1_wt
    s_load_dwordx2 s[4:5], s[0:1], 48
    s_mov_b32 s6, 16384
    s_mov_b32 s7, 0x00020000
    s_load_dwordx2 s[8:9], s[0:1], 56
    s_mov_b32 s10, 24576
    s_mov_b32 s11, 0x00020000
    v_lshrrev_b32 v1, 6, v0
    s_nop 0
    v_readfirstlane_b32 s20, v1
    s_sub_u32 s21, s2, 256
    s_mul_i32 s21, s21, 10
    s_add_u32 s20, s20, s21
    s_lshr_b32 s21, s20, 2
    s_and_b32 s22, s20, 3
    s_waitcnt lgkmcnt(0)
    s_cmp_lt_u32 s21, 4
    s_cselect_b32 s12, s4, s8
    s_cselect_b32 s13, s5, s9
    s_cselect_b32 s14, s6, s10
    s_mov_b32 s15, 0x00020000
    s_cselect_b32 s23, 0, 4
    s_sub_u32 s21, s21, s23
    s_cmp_lt_u32 s21, 4
    s_mov_b32 s24, 0x80
    s_cmov_b32 s24, 0x2000
    s_mov_b32 s25, 0x100
    s_cmov_b32 s25, 0x80
    s_cselect_b32 s26, 6, 7
    v_and_b32 v1, 63, v0
    v_lshrrev_b32 v2, 4, v1
    v_lshlrev_b32 v2, 3, v2
    s_lshl_b32 s27, s21, 5
    v_add_u32 v2, s27, v2
    v_lshlrev_b32 v2, s26, v2
    v_and_b32 v3, 15, v1
    s_lshl_b32 s27, s22, 4
    v_add_u32 v3, s27, v3
    v_lshl_add_u32 v4, v3, 1, v2
    v_add_u32 v5, s25, v4
    v_add_u32 v6, s25, v5
    v_add_u32 v7, s25, v6
    v_add_u32 v20, s24, v4
    v_add_u32 v21, s24, v5
    v_add_u32 v22, s24, v6
    v_add_u32 v23, s24, v7
    buffer_load_ushort v8, v4, s[12:15], 0 offen
    buffer_load_ushort v9, v20, s[12:15], 0 offen
    buffer_load_ushort v10, v5, s[12:15], 0 offen
    buffer_load_ushort v11, v21, s[12:15], 0 offen
    buffer_load_ushort v12, v6, s[12:15], 0 offen
    buffer_load_ushort v13, v22, s[12:15], 0 offen
    buffer_load_ushort v14, v7, s[12:15], 0 offen
    buffer_load_ushort v15, v23, s[12:15], 0 offen
    s_lshl_b32 s27, s20, 10
    s_add_u32 s27, s27, 8781824
    v_lshlrev_b32 v1, 4, v1
    v_add_u32 v1, s27, v1
    s_waitcnt vmcnt(0)
    v_lshl_or_b32 v16, v9, 16, v8
    v_lshl_or_b32 v17, v11, 16, v10
    v_lshl_or_b32 v18, v13, 16, v12
    v_lshl_or_b32 v19, v15, 16, v14
    buffer_store_dwordx4 v[16:19], v1, s[16:19], 0 offen
    s_endpgm
k1_wt:
    s_load_dwordx2 s[4:5], s[0:1], 40
    s_mov_b32 s6, 10240
    s_mov_b32 s7, 0x00020000
    s_sub_u32 s21, s2, 260
    s_mul_i32 s21, s21, 640
    v_add_u32 v1, s21, v0
    v_and_b32 v2, 63, v1
    v_bfe_u32 v3, v1, 6, 2
    v_lshrrev_b32 v4, 8, v1
    v_lshl_add_u32 v2, v4, 6, v2
    v_lshlrev_b32 v2, 1, v2
    v_mul_u32_u24 v3, 2560, v3
    v_add_u32 v2, v2, v3
    s_waitcnt lgkmcnt(0)
    buffer_load_ushort v4, v2, s[4:7], 0 offen
    buffer_load_ushort v5, v2, s[4:7], 0 offen offset:640
    buffer_load_ushort v6, v2, s[4:7], 0 offen offset:1280
    buffer_load_ushort v7, v2, s[4:7], 0 offen offset:1920
    v_lshlrev_b32 v1, 4, v1
    v_add_u32 v1, 8716288, v1
    s_waitcnt vmcnt(0)
    v_lshlrev_b32 v4, 16, v4
    v_lshlrev_b32 v5, 16, v5
    v_lshlrev_b32 v6, 16, v6
    v_lshlrev_b32 v7, 16, v7
    buffer_store_dwordx4 v[4:7], v1, s[16:19], 0 offen
k1_end:
    s_endpgm
.globl k2_kernel
.p2align 8
.type k2_kernel,@function
k2_kernel:
    s_cmp_ge_u32 s2, 250
    s_cbranch_scc1 k2_end
    s_load_dwordx2 s[12:13], s[0:1], 88
    s_mov_b32 s14, 268435456
    s_mov_b32 s15, 0x00020000
    s_load_dwordx2 s[4:5], s[0:1], 0
    s_mov_b32 s6, 5123072
    s_mov_b32 s7, 0x00020000
    s_load_dwordx2 s[8:9], s[0:1], 16
    s_mov_b32 s10, 20480000
    s_mov_b32 s11, 0x00020000
    s_load_dwordx2 s[16:17], s[0:1], 72
    s_mov_b32 s18, 5120000
    s_mov_b32 s19, 0x00020000
    v_lshrrev_b32 v2, 6, v0
    v_and_b32 v1, 63, v0
    v_readfirstlane_b32 s3, v2
    s_and_b32 s74, s2, 7
    s_lshl_b32 s74, s74, 5
    s_lshr_b32 s75, s2, 3
    s_add_u32 s74, s74, s75
    s_lshl_b32 s74, s74, 2
    s_add_u32 s74, s74, 8388608
    s_lshl_b32 s75, s3, 15
    s_add_u32 s74, s74, s75
    v_and_b32 v2, 31, v0
    v_lshlrev_b32 v2, 10, v2
    v_add_u32 v2, s74, v2
    s_lshl_b32 s67, s3, 13
    s_lshl_b32 s68, s3, 12
    s_add_u32 s68, s68, 65536
    s_movk_i32 s78, 512
    s_mov_b32 s83, 0xffff0000
    s_mov_b32 s20, 0
    s_mov_b32 s21, 32
    s_mov_b32 s22, 0
    s_mov_b32 s82, 1
    s_mov_b32 s86, 400000
    v_lshlrev_b32 v3, 4, v1
    s_lshl_b32 s75, s3, 10
    s_add_u32 s76, s75, 8716288
    v_add_u32 v4, s76, v3
    s_add_u32 s75, s75, 98304
    s_mov_b32 m0, s75
    s_waitcnt lgkmcnt(0)
    s_sub_u32 s4, s4, 3072
    s_subb_u32 s5, s5, 0
    buffer_load_dword v126, v2, s[12:15], 0 offen
    buffer_load_dwordx4 v4, s[12:15], 0 offen lds
    s_add_u32 m0, s75, 8192
    v_add_u32 v5, 8192, v4
    buffer_load_dwordx4 v5, s[12:15], 0 offen lds
    s_cmp_ge_u32 s3, 4
    s_cbranch_scc1 k2_w2
    s_add_u32 m0, s75, 16384
    v_add_u32 v5, 16384, v4
    buffer_load_dwordx4 v5, s[12:15], 0 offen lds
k2_w2:
    v_bfe_u32 v2, v1, 2, 2
    v_and_b32 v3, 3, v1
    v_lshrrev_b32 v4, 5, v1
    v_bfe_u32 v5, v1, 4, 1
    v_lshlrev_b32 v6, 10, v2
    v_lshl_add_u32 v6, v4, 9, v6
    v_lshl_add_u32 v6, v5, 5, v6
    v_lshl_add_u32 v6, v3, 3, v6
    v_add_u32 v6, s67, v6
    v_xor_b32 v7, 0, v2
    v_lshl_add_u32 v18, v7, 6, v6
    v_xor_b32 v7, 1, v2
    v_lshl_add_u32 v19, v7, 6, v6
    v_xor_b32 v7, 2, v2
    v_lshl_add_u32 v20, v7, 6, v6
    v_xor_b32 v7, 3, v2
    v_lshl_add_u32 v21, v7, 6, v6
    v_and_b32 v7, 15, v1
    v_xor_b32 v8, 0, v7
    v_lshlrev_b32 v8, 4, v8
    v_add_u32 v22, 3072, v8
    v_xor_b32 v8, 4, v7
    v_lshlrev_b32 v8, 4, v8
    v_add_u32 v23, 2048, v8
    v_xor_b32 v8, 8, v7
    v_lshlrev_b32 v8, 4, v8
    v_add_u32 v24, 1024, v8
    v_xor_b32 v8, 12, v7
    v_lshlrev_b32 v8, 4, v8
    v_add_u32 v25, 0, v8
    v_lshrrev_b32 v8, 1, v2
    v_lshlrev_b32 v8, 5, v8
    v_lshl_add_u32 v8, v4, 8, v8
    v_lshl_add_u32 v8, v3, 3, v8
    v_add_u32 v8, s68, v8
    v_lshlrev_b32 v9, 3, v3
    v_add_u32 v9, 161920, v9
    v_and_b32 v10, 1, v2
    v_cmp_eq_u32 vcc, 1, v10
    v_mov_b32 v11, 0xc00
    s_nop 0
    v_cndmask_b32 v26, v9, v8, vcc
    v_cndmask_b32 v27, 0, v11, vcc
    v_lshlrev_b32 v8, 4, v1
    v_add_u32 v39, s68, v8
k2_round:
    v_lshlrev_b32 v2, 4, v0
    v_add_u32 v3, 118784, v2
    v_mov_b32 v4, 0
    v_mov_b32 v5, s83
    v_mov_b32 v6, 0
    v_mov_b32 v7, s83
    v_mov_b32 v8, 0x7fffff00
    v_mov_b32 v9, 0x7fffff00
    v_mov_b32 v10, 0x7fffff00
    v_mov_b32 v11, 0x7fffff00
    ds_write_b128 v3, v[4:7]
    ds_write_b128 v3, v[4:7] offset:8192
    ds_write_b128 v3, v[4:7] offset:16384
    ds_write_b128 v3, v[8:11] offset:28672
    s_cmp_ge_u32 s3, 6
    s_cbranch_scc1 k2_pf_done
    ds_write_b128 v3, v[8:11] offset:36864
    s_cmp_ge_u32 s3, 4
    s_cbranch_scc1 k2_pf_done
    ds_write_b128 v3, v[4:7] offset:24576
    s_cmp_ge_u32 s3, 2
    s_cbranch_scc1 k2_pf_done
    v_cmp_eq_u32 vcc, 127, v0
    v_mov_b32 v12, 0x3f80
    v_mov_b32 v13, 0
    v_cndmask_b32 v12, 0, v12, vcc
    v_mov_b32 v14, 0
    v_mov_b32 v15, 0
    ds_write_b128 v3, v[12:15] offset:43008
k2_pf_done:
    v_lshrrev_b32 v2, 4, v1
    v_lshlrev_b32 v3, 2, v2
    s_lshl_b32 s74, s3, 5
    v_add_u32 v2, s74, v2
    v_mul_u32_u24 v2, 30080, v2
    v_and_b32 v4, 15, v1
    v_add_u32 v4, s20, v4
    v_mad_u32_u24 v2, v4, 12, v2
    v_add_u32 v5, 16, v4
    s_add_u32 s75, s20, s21
    s_waitcnt lgkmcnt(0)
    s_barrier
    s_waitcnt vmcnt(0)
    ds_bpermute_b32 v208, v3, v126 offset:0
    ds_bpermute_b32 v209, v3, v126 offset:16
    ds_bpermute_b32 v210, v3, v126 offset:32
    ds_bpermute_b32 v211, v3, v126 offset:48
    ds_bpermute_b32 v212, v3, v126 offset:64
    ds_bpermute_b32 v213, v3, v126 offset:80
    ds_bpermute_b32 v214, v3, v126 offset:96
    ds_bpermute_b32 v215, v3, v126 offset:112
    v_lshrrev_b32 v6, 16, v126
    v_cmp_lt_u32 vcc, s75, v6
    s_cmp_eq_u64 vcc, 0
    s_cbranch_scc1 k2_noflag
    v_mov_b32 v6, 163072
    v_mov_b32 v7, 1
    ds_write_b32 v6, v7
k2_noflag:
    s_waitcnt lgkmcnt(0)
    v_lshrrev_b32 v6, 16, v208
    v_and_b32 v7, 0xffff, v208
    v_min_u32 v6, s75, v6
    v_mad_u32_u24 v208, v7, 12, v2
    v_cmp_lt_u32 s[32:33], v4, v6
    v_cmp_lt_u32 s[34:35], v5, v6
    v_add_u32 v208, 0, v208
    s_mov_b64 exec, s[32:33]
    s_cbranch_execz k2_ld0
    buffer_load_dwordx3 v[128:130], v208, s[12:15], 0 offen
    s_mov_b64 exec, s[34:35]
    s_cbranch_execz k2_ld0
    buffer_load_dwordx3 v[132:134], v208, s[12:15], 0 offen offset:192
k2_ld0:
    s_mov_b64 exec, -1
    v_lshrrev_b32 v6, 16, v209
    v_and_b32 v7, 0xffff, v209
    v_min_u32 v6, s75, v6
    v_mad_u32_u24 v209, v7, 12, v2
    v_cmp_lt_u32 s[36:37], v4, v6
    v_cmp_lt_u32 s[38:39], v5, v6
    v_add_u32 v209, 120320, v209
    s_mov_b64 exec, s[36:37]
    s_cbranch_execz k2_ld1
    buffer_load_dwordx3 v[136:138], v209, s[12:15], 0 offen
    s_mov_b64 exec, s[38:39]
    s_cbranch_execz k2_ld1
    buffer_load_dwordx3 v[140:142], v209, s[12:15], 0 offen offset:192
k2_ld1:
    s_mov_b64 exec, -1
    v_lshrrev_b32 v6, 16, v210
    v_and_b32 v7, 0xffff, v210
    v_min_u32 v6, s75, v6
    v_mad_u32_u24 v210, v7, 12, v2
    v_cmp_lt_u32 s[40:41], v4, v6
    v_cmp_lt_u32 s[42:43], v5, v6
    v_add_u32 v210, 240640, v210
    s_mov_b64 exec, s[40:41]
    s_cbranch_execz k2_ld2
    buffer_load_dwordx3 v[144:146], v210, s[12:15], 0 offen
    s_mov_b64 exec, s[42:43]
    s_cbranch_execz k2_ld2
    buffer_load_dwordx3 v[148:150], v210, s[12:15], 0 offen offset:192
k2_ld2:
    s_mov_b64 exec, -1
    v_lshrrev_b32 v6, 16, v211
    v_and_b32 v7, 0xffff, v211
    v_min_u32 v6, s75, v6
    v_mad_u32_u24 v211, v7, 12, v2
    v_cmp_lt_u32 s[44:45], v4, v6
    v_cmp_lt_u32 s[46:47], v5, v6
    v_add_u32 v211, 360960, v211
    s_mov_b64 exec, s[44:45]
    s_cbranch_execz k2_ld3
    buffer_load_dwordx3 v[152:154], v211, s[12:15], 0 offen
    s_mov_b64 exec, s[46:47]
    s_cbranch_execz k2_ld3
    buffer_load_dwordx3 v[156:158], v211, s[12:15], 0 offen offset:192
k2_ld3:
    s_mov_b64 exec, -1
    v_lshrrev_b32 v6, 16, v212
    v_and_b32 v7, 0xffff, v212
    v_min_u32 v6, s75, v6
    v_mad_u32_u24 v212, v7, 12, v2
    v_cmp_lt_u32 s[48:49], v4, v6
    v_cmp_lt_u32 s[50:51], v5, v6
    v_add_u32 v212, 481280, v212
    s_mov_b64 exec, s[48:49]
    s_cbranch_execz k2_ld4
    buffer_load_dwordx3 v[160:162], v212, s[12:15], 0 offen
    s_mov_b64 exec, s[50:51]
    s_cbranch_execz k2_ld4
    buffer_load_dwordx3 v[164:166], v212, s[12:15], 0 offen offset:192
k2_ld4:
    s_mov_b64 exec, -1
    v_lshrrev_b32 v6, 16, v213
    v_and_b32 v7, 0xffff, v213
    v_min_u32 v6, s75, v6
    v_mad_u32_u24 v213, v7, 12, v2
    v_cmp_lt_u32 s[52:53], v4, v6
    v_cmp_lt_u32 s[54:55], v5, v6
    v_add_u32 v213, 601600, v213
    s_mov_b64 exec, s[52:53]
    s_cbranch_execz k2_ld5
    buffer_load_dwordx3 v[168:170], v213, s[12:15], 0 offen
    s_mov_b64 exec, s[54:55]
    s_cbranch_execz k2_ld5
    buffer_load_dwordx3 v[172:174], v213, s[12:15], 0 offen offset:192
k2_ld5:
    s_mov_b64 exec, -1
    v_lshrrev_b32 v6, 16, v214
    v_and_b32 v7, 0xffff, v214
    v_min_u32 v6, s75, v6
    v_mad_u32_u24 v214, v7, 12, v2
    v_cmp_lt_u32 s[56:57], v4, v6
    v_cmp_lt_u32 s[58:59], v5, v6
    v_add_u32 v214, 721920, v214
    s_mov_b64 exec, s[56:57]
    s_cbranch_execz k2_ld6
    buffer_load_dwordx3 v[176:178], v214, s[12:15], 0 offen
    s_mov_b64 exec, s[58:59]
    s_cbranch_execz k2_ld6
    buffer_load_dwordx3 v[180:182], v214, s[12:15], 0 offen offset:192
k2_ld6:
    s_mov_b64 exec, -1
    v_lshrrev_b32 v6, 16, v215
    v_and_b32 v7, 0xffff, v215
    v_min_u32 v6, s75, v6
    v_mad_u32_u24 v215, v7, 12, v2
    v_cmp_lt_u32 s[60:61], v4, v6
    v_cmp_lt_u32 s[62:63], v5, v6
    v_add_u32 v215, 842240, v215
    s_mov_b64 exec, s[60:61]
    s_cbranch_execz k2_ld7
    buffer_load_dwordx3 v[184:186], v215, s[12:15], 0 offen
    s_mov_b64 exec, s[62:63]
    s_cbranch_execz k2_ld7
    buffer_load_dwordx3 v[188:190], v215, s[12:15], 0 offen offset:192
k2_ld7:
    s_mov_b64 exec, -1
    v_mov_b32 v6, 1
    v_mov_b32 v7, 131072
    s_waitcnt vmcnt(0)
    s_mov_b64 exec, s[32:33]
    s_cbranch_execz k2_h0
    v_lshrrev_b32 v8, 26, v130
    v_lshl_add_u32 v192, v8, 2, v7
    ds_add_rtn_u32 v131, v192, v6 offset:31744
    s_mov_b64 exec, s[34:35]
    s_cbranch_execz k2_h0
    v_lshrrev_b32 v8, 26, v134
    v_lshl_add_u32 v193, v8, 2, v7
    ds_add_rtn_u32 v135, v193, v6 offset:31744
k2_h0:
    s_mov_b64 exec, s[36:37]
    s_cbranch_execz k2_h1
    v_lshrrev_b32 v8, 26, v138
    v_lshl_add_u32 v194, v8, 2, v7
    ds_add_rtn_u32 v139, v194, v6 offset:31744
    s_mov_b64 exec, s[38:39]
    s_cbranch_execz k2_h1
    v_lshrrev_b32 v8, 26, v142
    v_lshl_add_u32 v195, v8, 2, v7
    ds_add_rtn_u32 v143, v195, v6 offset:31744
k2_h1:
    s_mov_b64 exec, s[40:41]
    s_cbranch_execz k2_h2
    v_lshrrev_b32 v8, 26, v146
    v_lshl_add_u32 v196, v8, 2, v7
    ds_add_rtn_u32 v147, v196, v6 offset:31744
    s_mov_b64 exec, s[42:43]
    s_cbranch_execz k2_h2
    v_lshrrev_b32 v8, 26, v150
    v_lshl_add_u32 v197, v8, 2, v7
    ds_add_rtn_u32 v151, v197, v6 offset:31744
k2_h2:
    s_mov_b64 exec, s[44:45]
    s_cbranch_execz k2_h3
    v_lshrrev_b32 v8, 26, v154
    v_lshl_add_u32 v198, v8, 2, v7
    ds_add_rtn_u32 v155, v198, v6 offset:31744
    s_mov_b64 exec, s[46:47]
    s_cbranch_execz k2_h3
    v_lshrrev_b32 v8, 26, v158
    v_lshl_add_u32 v199, v8, 2, v7
    ds_add_rtn_u32 v159, v199, v6 offset:31744
k2_h3:
    s_mov_b64 exec, s[48:49]
    s_cbranch_execz k2_h4
    v_lshrrev_b32 v8, 26, v162
    v_lshl_add_u32 v200, v8, 2, v7
    ds_add_rtn_u32 v163, v200, v6 offset:31744
    s_mov_b64 exec, s[50:51]
    s_cbranch_execz k2_h4
    v_lshrrev_b32 v8, 26, v166
    v_lshl_add_u32 v201, v8, 2, v7
    ds_add_rtn_u32 v167, v201, v6 offset:31744
k2_h4:
    s_mov_b64 exec, s[52:53]
    s_cbranch_execz k2_h5
    v_lshrrev_b32 v8, 26, v170
    v_lshl_add_u32 v202, v8, 2, v7
    ds_add_rtn_u32 v171, v202, v6 offset:31744
    s_mov_b64 exec, s[54:55]
    s_cbranch_execz k2_h5
    v_lshrrev_b32 v8, 26, v174
    v_lshl_add_u32 v203, v8, 2, v7
    ds_add_rtn_u32 v175, v203, v6 offset:31744
k2_h5:
    s_mov_b64 exec, s[56:57]
    s_cbranch_execz k2_h6
    v_lshrrev_b32 v8, 26, v178
    v_lshl_add_u32 v204, v8, 2, v7
    ds_add_rtn_u32 v179, v204, v6 offset:31744
    s_mov_b64 exec, s[58:59]
    s_cbranch_execz k2_h6
    v_lshrrev_b32 v8, 26, v182
    v_lshl_add_u32 v205, v8, 2, v7
    ds_add_rtn_u32 v183, v205, v6 offset:31744
k2_h6:
    s_mov_b64 exec, s[60:61]
    s_cbranch_execz k2_h7
    v_lshrrev_b32 v8, 26, v186
    v_lshl_add_u32 v206, v8, 2, v7
    ds_add_rtn_u32 v187, v206, v6 offset:31744
    s_mov_b64 exec, s[62:63]
    s_cbranch_execz k2_h7
    v_lshrrev_b32 v8, 26, v190
    v_lshl_add_u32 v207, v8, 2, v7
    ds_add_rtn_u32 v191, v207, v6 offset:31744
k2_h7:
    s_mov_b64 exec, s[32:33]
    v_bfe_u32 v8, v130, 26, 3
    v_and_b32 v9, 0x3ffffff, v130
    v_cmpx_gt_u32 vcc, 1, v8
    s_cbranch_execz k2_pa0
    buffer_load_dword v216, v9, s[8:11], 0 offen
k2_pa0:
    s_mov_b64 exec, s[36:37]
    v_bfe_u32 v8, v138, 26, 3
    v_and_b32 v9, 0x3ffffff, v138
    v_cmpx_gt_u32 vcc, 1, v8
    s_cbranch_execz k2_pa1
    buffer_load_dword v217, v9, s[8:11], 0 offen
k2_pa1:
    s_mov_b64 exec, s[40:41]
    v_bfe_u32 v8, v146, 26, 3
    v_and_b32 v9, 0x3ffffff, v146
    v_cmpx_gt_u32 vcc, 1, v8
    s_cbranch_execz k2_pa2
    buffer_load_dword v218, v9, s[8:11], 0 offen
k2_pa2:
    s_mov_b64 exec, s[44:45]
    v_bfe_u32 v8, v154, 26, 3
    v_and_b32 v9, 0x3ffffff, v154
    v_cmpx_gt_u32 vcc, 1, v8
    s_cbranch_execz k2_pa3
    buffer_load_dword v219, v9, s[8:11], 0 offen
k2_pa3:
    s_mov_b64 exec, -1
    v_lshl_add_u32 v8, v1, 2, v7
    v_mov_b32 v9, 163072
    s_waitcnt lgkmcnt(0)
    s_barrier
    ds_read_b32 v10, v8 offset:31744
    ds_read_b32 v11, v9
    v_and_b32 v12, 7, v1
    v_cmp_gt_u32 s[76:77], 5, v12
    v_cmp_eq_u32 s[74:75], 4, v12
    v_and_b32 v13, 56, v1
    s_waitcnt lgkmcnt(0)
    v_add_u32 v10, 15, v10
    v_lshrrev_b32 v10, 4, v10
    v_max_u32 v10, 1, v10
    v_cndmask_b32 v10, 0, v10, s[76:77]
    v_mov_b32 v224, v1
    s_cmp_lg_u32 s22, 0
    s_cbranch_scc1 k2_nobal
    v_and_b32 v225, 1, v10
    v_cmp_le_u32 s[26:27], 5, v10
    v_cmp_eq_u32 s[24:25], 1, v225
    s_mov_b32 s30, 0x1e1e1e1e
    s_mov_b32 s31, 0x1e1e1e1e
    s_mov_b32 s64, 0x01010101
    s_mov_b32 s65, 0x01010101
    v_mbcnt_lo_u32_b32 v225, s30, 0
    v_mbcnt_hi_u32_b32 v225, s31, v225
    s_and_b64 s[70:71], s[24:25], s[30:31]
    s_and_b64 s[72:73], s[24:25], s[64:65]
    s_andn2_b64 s[80:81], s[64:65], s[24:25]
    s_and_b64 s[28:29], s[70:71], s[26:27]
    v_mbcnt_lo_u32_b32 v226, s70, 0
    v_mbcnt_hi_u32_b32 v226, s71, v226
    v_mbcnt_lo_u32_b32 v229, s72, 0
    v_mbcnt_hi_u32_b32 v229, s73, v229
    v_mbcnt_lo_u32_b32 v230, s80, 0
    v_mbcnt_hi_u32_b32 v230, s81, v230
    v_mbcnt_lo_u32_b32 v227, s28, 0
    v_mbcnt_hi_u32_b32 v227, s29, v227
    s_bcnt1_i32_b64 s66, s[70:71]
    s_bcnt1_i32_b64 s69, s[28:29]
    s_bcnt1_i32_b64 s72, s[72:73]
    v_sub_u32 v225, v225, v226
    v_sub_u32 v226, v226, v227
    v_add_u32 v225, s66, v225
    v_add_u32 v226, s69, v226
    v_add_u32 v230, s72, v230
    v_cndmask_b32 v225, v225, v226, s[70:71]
    v_cndmask_b32 v229, v230, v229, s[24:25]
    v_cndmask_b32 v225, v225, v227, s[28:29]
    v_lshlrev_b32 v229, 3, v229
    s_sub_u32 s73, 32, s72
    v_add_u32 v226, s72, v225
    v_cndmask_b32 v224, v224, v229, s[64:65]
    v_lshrrev_b32 v227, 1, v226
    v_and_b32 v228, 1, v226
    v_cmp_le_u32 s[24:25], 8, v227
    s_add_u32 s79, s72, 8
    v_and_b32 v229, 7, v227
    v_cmp_le_u32 s[26:27], s79, v227
    v_lshl_add_u32 v229, v229, 3, v228
    v_cmp_gt_u32 s[28:29], s72, v225
    v_addc_co_u32 v229, vcc, 1, v229, s[24:25]
    v_cmp_le_u32 s[70:71], s73, v225
    v_lshl_add_u32 v227, v225, 3, 1
    v_addc_co_u32 v229, vcc, 0, v229, s[26:27]
    v_subrev_u32 v228, s73, v225
    v_cndmask_b32 v229, v229, v227, s[28:29]
    v_lshl_add_u32 v228, v228, 3, 4
    v_cndmask_b32 v229, v229, v228, s[70:71]
    v_cndmask_b32 v224, v224, v229, s[30:31]
k2_nobal:
    v_lshlrev_b32 v224, 2, v224
    v_lshl_or_b32 v10, v1, 16, v10
    ds_permute_b32 v10, v224, v10
    v_lshl_add_u32 v226, v1, 1, v7
    s_waitcnt lgkmcnt(0)
    v_lshrrev_b32 v224, 16, v10
    v_and_b32 v10, 0xffff, v10
    v_lshl_add_u32 v8, v224, 2, v7
    v_lshrrev_b32 v225, 3, v224
    v_mad_i32_i24 v224, v225, -3, v224
    ds_write_b16 v226, v224 offset:32512
    v_and_b32 v14, 1, v10
    v_cmp_eq_u32 vcc, 1, v14
    v_readfirstlane_b32 s23, v11
    s_nop 0
    v_lshrrev_b64 v[14:15], v13, vcc
    v_and_b32 v14, 31, v14
    v_bcnt_u32_b32 v14, v14, 0
    v_and_b32 v14, 1, v14
    v_cndmask_b32 v14, 0, v14, s[74:75]
    v_add_u32 v10, v10, v14
    v_mov_b32 v11, v10
    s_nop 1
    v_add_u32_dpp v11, v11, v11 row_shr:1 row_mask:0xf bank_mask:0xf
    s_nop 1
    v_add_u32_dpp v11, v11, v11 row_shr:2 row_mask:0xf bank_mask:0xf
    s_nop 1
    v_add_u32_dpp v11, v11, v11 row_shr:4 row_mask:0xf bank_mask:0xf
    s_nop 1
    v_add_u32_dpp v11, v11, v11 row_shr:8 row_mask:0xf bank_mask:0xf
    s_nop 1
    v_add_u32_dpp v11, v11, v11 row_bcast:15 row_mask:0xa bank_mask:0xf
    s_nop 1
    v_add_u32_dpp v11, v11, v11 row_bcast:31 row_mask:0xc bank_mask:0xf
    v_sub_u32 v12, v11, v10
    v_lshlrev_b32 v12, 4, v12
    ds_write_b32 v8, v12 offset:32256
    v_readlane_b32 s74, v11, 63
    s_cmp_lg_u32 s22, 0
    s_cbranch_scc1 k2_fits
    s_cmp_gt_u32 s74, 224
    s_cbranch_scc1 k2_tofb
    s_cmp_eq_u32 s23, 0
    s_cbranch_scc1 k2_fits
k2_tofb:
    s_mov_b32 s22, 1
    s_mov_b32 s21, 8
    s_waitcnt lgkmcnt(0)
    s_barrier
    s_branch k2_round
k2_fits:
    s_mov_b64 exec, s[32:33]
    s_cbranch_execz k2_s0
    ds_read_b32 v192, v192 offset:32256
    s_mov_b64 exec, s[34:35]
    s_cbranch_execz k2_s0
    ds_read_b32 v193, v193 offset:32256
k2_s0:
    s_mov_b64 exec, s[36:37]
    s_cbranch_execz k2_s1
    ds_read_b32 v194, v194 offset:32256
    s_mov_b64 exec, s[38:39]
    s_cbranch_execz k2_s1
    ds_read_b32 v195, v195 offset:32256
k2_s1:
    s_mov_b64 exec, s[40:41]
    s_cbranch_execz k2_s2
    ds_read_b32 v196, v196 offset:32256
    s_mov_b64 exec, s[42:43]
    s_cbranch_execz k2_s2
    ds_read_b32 v197, v197 offset:32256
k2_s2:
    s_mov_b64 exec, s[44:45]
    s_cbranch_execz k2_s3
    ds_read_b32 v198, v198 offset:32256
    s_mov_b64 exec, s[46:47]
    s_cbranch_execz k2_s3
    ds_read_b32 v199, v199 offset:32256
k2_s3:
    s_mov_b64 exec, s[48:49]
    s_cbranch_execz k2_s4
    ds_read_b32 v200, v200 offset:32256
    s_mov_b64 exec, s[50:51]
    s_cbranch_execz k2_s4
    ds_read_b32 v201, v201 offset:32256
k2_s4:
    s_mov_b64 exec, s[52:53]
    s_cbranch_execz k2_s5
    ds_read_b32 v202, v202 offset:32256
    s_mov_b64 exec, s[54:55]
    s_cbranch_execz k2_s5
    ds_read_b32 v203, v203 offset:32256
k2_s5:
    s_mov_b64 exec, s[56:57]
    s_cbranch_execz k2_s6
    ds_read_b32 v204, v204 offset:32256
    s_mov_b64 exec, s[58:59]
    s_cbranch_execz k2_s6
    ds_read_b32 v205, v205 offset:32256
k2_s6:
    s_mov_b64 exec, s[60:61]
    s_cbranch_execz k2_s7
    ds_read_b32 v206, v206 offset:32256
    s_mov_b64 exec, s[62:63]
    s_cbranch_execz k2_s7
    ds_read_b32 v207, v207 offset:32256
k2_s7:
    s_mov_b64 exec, s[32:33]
    v_bfe_u32 v8, v130, 26, 3
    v_lshrrev_b32 v9, 16, v129
    v_cmpx_gt_u32 vcc, 1, v8
    s_cbranch_execz k2_px0
    v_lshlrev_b32 v9, 9, v9
    buffer_load_dword v232, v9, s[4:7], 0 offen offset:3072
    buffer_load_dword v240, v9, s[4:7], 0 offen offset:3200
k2_px0:
    s_mov_b64 exec, s[36:37]
    v_bfe_u32 v8, v138, 26, 3
    v_lshrrev_b32 v9, 16, v137
    v_cmpx_gt_u32 vcc, 1, v8
    s_cbranch_execz k2_px1
    v_lshlrev_b32 v9, 9, v9
    buffer_load_dword v233, v9, s[4:7], 0 offen offset:3072
    buffer_load_dword v241, v9, s[4:7], 0 offen offset:3200
k2_px1:
    s_mov_b64 exec, s[40:41]
    v_bfe_u32 v8, v146, 26, 3
    v_lshrrev_b32 v9, 16, v145
    v_cmpx_gt_u32 vcc, 1, v8
    s_cbranch_execz k2_px2
    v_lshlrev_b32 v9, 9, v9
    buffer_load_dword v234, v9, s[4:7], 0 offen offset:3072
    buffer_load_dword v242, v9, s[4:7], 0 offen offset:3200
k2_px2:
    s_mov_b64 exec, -1
    s_lshl_b32 s74, s3, 3
    v_mov_b32 v13, 118784
    v_mov_b32 v14, 147456
    v_readlane_b32 s81, v12, s74
    s_add_u32 s75, s74, 7
    v_readlane_b32 s24, v11, s75
    s_add_u32 s75, s74, 4
    v_readlane_b32 s76, v10, s75
    s_cmp_eq_u32 s76, 0
    s_cselect_b32 s84, 16, 20
    s_mov_b32 s28, s76
    s_mov_b32 s29, 0
    s_add_u32 s75, s74, 3
    v_readlane_b32 s76, v10, s75
    s_lshl_b64 s[28:29], s[28:29], 12
    s_or_b32 s28, s28, s76
    s_add_u32 s75, s74, 2
    v_readlane_b32 s76, v10, s75
    s_lshl_b64 s[28:29], s[28:29], 12
    s_or_b32 s28, s28, s76
    s_add_u32 s75, s74, 1
    v_readlane_b32 s76, v10, s75
    s_lshl_b64 s[28:29], s[28:29], 12
    s_or_b32 s28, s28, s76
    s_add_u32 s75, s74, 0
    v_readlane_b32 s76, v10, s75
    s_lshl_b64 s[28:29], s[28:29], 12
    s_or_b32 s28, s28, s76
    s_sub_u32 s28, s28, 0x01001001
    s_subb_u32 s29, s29, 0x00010010
    s_lshr_b32 s75, s81, 4
    s_sub_u32 s24, s24, s75
    s_lshr_b32 s25, s24, 1
    s_mov_b32 s77, 0x3ffffff
    s_waitcnt lgkmcnt(0)
    s_mov_b64 exec, s[32:33]
    s_cbranch_execz k2_t0
    v_add_u32 v8, v192, v131
    v_lshl_add_u32 v9, v8, 3, v13
    v_lshl_add_u32 v8, v8, 2, v14
    v_and_b32 v130, s77, v130
    ds_write2_b32 v9, v128, v129 offset0:0 offset1:1
    ds_write_b32 v8, v130
    s_mov_b64 exec, s[34:35]
    s_cbranch_execz k2_t0
    v_add_u32 v8, v193, v135
    v_lshl_add_u32 v9, v8, 3, v13
    v_lshl_add_u32 v8, v8, 2, v14
    v_and_b32 v134, s77, v134
    ds_write2_b32 v9, v132, v133 offset0:0 offset1:1
    ds_write_b32 v8, v134
k2_t0:
    s_mov_b64 exec, s[36:37]
    s_cbranch_execz k2_t1
    v_add_u32 v8, v194, v139
    v_lshl_add_u32 v9, v8, 3, v13
    v_lshl_add_u32 v8, v8, 2, v14
    v_and_b32 v138, s77, v138
    ds_write2_b32 v9, v136, v137 offset0:0 offset1:1
    ds_write_b32 v8, v138
    s_mov_b64 exec, s[38:39]
    s_cbranch_execz k2_t1
    v_add_u32 v8, v195, v143
    v_lshl_add_u32 v9, v8, 3, v13
    v_lshl_add_u32 v8, v8, 2, v14
    v_and_b32 v142, s77, v142
    ds_write2_b32 v9, v140, v141 offset0:0 offset1:1
    ds_write_b32 v8, v142
k2_t1:
    s_mov_b64 exec, s[40:41]
    s_cbranch_execz k2_t2
    v_add_u32 v8, v196, v147
    v_lshl_add_u32 v9, v8, 3, v13
    v_lshl_add_u32 v8, v8, 2, v14
    v_and_b32 v146, s77, v146
    ds_write2_b32 v9, v144, v145 offset0:0 offset1:1
    ds_write_b32 v8, v146
    s_mov_b64 exec, s[42:43]
    s_cbranch_execz k2_t2
    v_add_u32 v8, v197, v151
    v_lshl_add_u32 v9, v8, 3, v13
    v_lshl_add_u32 v8, v8, 2, v14
    v_and_b32 v150, s77, v150
    ds_write2_b32 v9, v148, v149 offset0:0 offset1:1
    ds_write_b32 v8, v150
k2_t2:
    s_mov_b64 exec, s[44:45]
    s_cbranch_execz k2_t3
    v_add_u32 v8, v198, v155
    v_lshl_add_u32 v9, v8, 3, v13
    v_lshl_add_u32 v8, v8, 2, v14
    v_and_b32 v154, s77, v154
    ds_write2_b32 v9, v152, v153 offset0:0 offset1:1
    ds_write_b32 v8, v154
    s_mov_b64 exec, s[46:47]
    s_cbranch_execz k2_t3
    v_add_u32 v8, v199, v159
    v_lshl_add_u32 v9, v8, 3, v13
    v_lshl_add_u32 v8, v8, 2, v14
    v_and_b32 v158, s77, v158
    ds_write2_b32 v9, v156, v157 offset0:0 offset1:1
    ds_write_b32 v8, v158
k2_t3:
    s_mov_b64 exec, s[48:49]
    s_cbranch_execz k2_t4
    v_add_u32 v8, v200, v163
    v_lshl_add_u32 v9, v8, 3, v13
    v_lshl_add_u32 v8, v8, 2, v14
    v_and_b32 v162, s77, v162
    ds_write2_b32 v9, v160, v161 offset0:0 offset1:1
    ds_write_b32 v8, v162
    s_mov_b64 exec, s[50:51]
    s_cbranch_execz k2_t4
    v_add_u32 v8, v201, v167
    v_lshl_add_u32 v9, v8, 3, v13
    v_lshl_add_u32 v8, v8, 2, v14
    v_and_b32 v166, s77, v166
    ds_write2_b32 v9, v164, v165 offset0:0 offset1:1
    ds_write_b32 v8, v166
k2_t4:
    s_mov_b64 exec, s[52:53]
    s_cbranch_execz k2_t5
    v_add_u32 v8, v202, v171
    v_lshl_add_u32 v9, v8, 3, v13
    v_lshl_add_u32 v8, v8, 2, v14
    v_and_b32 v170, s77, v170
    ds_write2_b32 v9, v168, v169 offset0:0 offset1:1
    ds_write_b32 v8, v170
    s_mov_b64 exec, s[54:55]
    s_cbranch_execz k2_t5
    v_add_u32 v8, v203, v175
    v_lshl_add_u32 v9, v8, 3, v13
    v_lshl_add_u32 v8, v8, 2, v14
    v_and_b32 v174, s77, v174
    ds_write2_b32 v9, v172, v173 offset0:0 offset1:1
    ds_write_b32 v8, v174
k2_t5:
    s_mov_b64 exec, s[56:57]
    s_cbranch_execz k2_t6
    v_add_u32 v8, v204, v179
    v_lshl_add_u32 v9, v8, 3, v13
    v_lshl_add_u32 v8, v8, 2, v14
    v_and_b32 v178, s77, v178
    ds_write2_b32 v9, v176, v177 offset0:0 offset1:1
    ds_write_b32 v8, v178
    s_mov_b64 exec, s[58:59]
    s_cbranch_execz k2_t6
    v_add_u32 v8, v205, v183
    v_lshl_add_u32 v9, v8, 3, v13
    v_lshl_add_u32 v8, v8, 2, v14
    v_and_b32 v182, s77, v182
    ds_write2_b32 v9, v180, v181 offset0:0 offset1:1
    ds_write_b32 v8, v182
k2_t6:
    s_mov_b64 exec, s[60:61]
    s_cbranch_execz k2_t7
    v_add_u32 v8, v206, v187
    v_lshl_add_u32 v9, v8, 3, v13
    v_lshl_add_u32 v8, v8, 2, v14
    v_and_b32 v186, s77, v186
    ds_write2_b32 v9, v184, v185 offset0:0 offset1:1
    ds_write_b32 v8, v186
    s_mov_b64 exec, s[62:63]
    s_cbranch_execz k2_t7
    v_add_u32 v8, v207, v191
    v_lshl_add_u32 v9, v8, 3, v13
    v_lshl_add_u32 v8, v8, 2, v14
    v_and_b32 v190, s77, v190
    ds_write2_b32 v9, v188, v189 offset0:0 offset1:1
    ds_write_b32 v8, v190
k2_t7:
    s_mov_b64 exec, -1
    s_lshl_b32 s74, s81, 3
    s_add_u32 s74, s74, 118784
    v_lshrrev_b32 v2, 4, v1
    v_lshlrev_b32 v3, 5, v2
    v_add_u32 v31, s74, v3
    s_lshl_b32 s75, s81, 2
    s_add_u32 s75, s75, 147456
    v_lshrrev_b32 v3, 1, v1
    v_lshlrev_b32 v3, 2, v3
    v_add_u32 v32, s75, v3
    s_sub_u32 s80, s25, 3
    s_min_u32 s71, s80, 10
    s_and_b32 s79, s25, 3
    s_lshl_b32 s79, s79, 10
    s_lshl_b32 s66, s24, 7
    s_sub_u32 s66, 256, s66
    s_sub_u32 s27, s24, 4
    s_mov_b32 s64, 0
    s_mov_b32 s6, 5123072
    s_mov_b32 s10, 20480000
    v_mov_b32 v38, 0
    s_lshl_b32 s74, s81, 3
    s_add_u32 s74, s74, 118782
    v_bfe_u32 v48, v1, 3, 1
    v_bfe_u32 v49, v1, 4, 1
    v_lshl_add_u32 v48, v48, 1, v49
    v_and_b32 v49, 7, v1
    v_lshrrev_b32 v50, 5, v1
    v_lshl_add_u32 v49, v50, 3, v49
    v_lshlrev_b32 v49, 3, v49
    v_lshl_add_u32 v49, v48, 1, v49
    v_add_u32 v49, s74, v49
    v_cmp_eq_u32 vcc, 0, v48
    v_mov_b32 v50, 163824
    v_mov_b32 v51, 0x80
    v_cndmask_b32 v30, v49, v50, vcc
    v_cndmask_b32 v29, v51, 0, vcc
    s_waitcnt lgkmcnt(0)
    s_barrier
    s_cmp_ge_u32 s3, 4
    s_cselect_b32 s34, 69905, 0
    s_mov_b64 s[30:31], s[28:29]
    s_and_b32 s26, s30, 0xfff
    s_mov_b32 s72, 0
    s_mov_b32 s73, 0
    s_mov_b32 s70, 0
    ds_read_b32 v48, v32
    ds_read_b32 v49, v32 offset:128
    ds_read_b32 v50, v32 offset:256
    ds_read_b32 v33, v32 offset:384
    ds_read2_b32 v[34:35], v31 offset0:1 offset1:3
    ds_read2_b32 v[36:37], v31 offset0:5 offset1:7
    ds_read2_b32 v[52:53], v31 offset0:33 offset1:35
    ds_read2_b32 v[54:55], v31 offset0:37 offset1:39
    v_add_u32 v32, 0x200, v32
    v_add_u32 v31, 0x100, v31
    s_mov_b32 s69, 3
    s_waitcnt lgkmcnt(4)
    s_add_u32 m0, s68, 0
    v_and_or_b32 v48, v22, 16, v48
    buffer_load_dwordx4 v48, s[8:11], 0 offen  lds
    s_add_u32 m0, s68, 1024
    v_and_or_b32 v49, v22, 16, v49
    buffer_load_dwordx4 v49, s[8:11], 0 offen  lds
    s_mov_b32 m0, s67
    s_waitcnt lgkmcnt(0)
    v_mad_u32_u16 v34, v34, s78, v22 op_sel:[1,0,0,0]
    v_mad_u32_u16 v35, v35, s78, v23 op_sel:[1,0,0,0]
    v_mad_u32_u16 v36, v36, s78, v24 op_sel:[1,0,0,0]
    v_mad_u32_u16 v37, v37, s78, v25 op_sel:[1,0,0,0]
    buffer_load_dwordx4 v34, s[4:7], s64 offen offset:0 lds
    buffer_load_dwordx4 v35, s[4:7], s64 offen offset:1024 lds
    buffer_load_dwordx4 v36, s[4:7], s64 offen offset:2048 lds
    buffer_load_dwordx4 v37, s[4:7], s64 offen offset:3072 lds
    s_add_u32 m0, s68, 2048
    v_and_or_b32 v50, v22, 16, v50
    buffer_load_dwordx4 v50, s[8:11], 0 offen  lds
    v_mad_u32_u16 v52, v52, s78, v22 op_sel:[1,0,0,0]
    v_mad_u32_u16 v53, v53, s78, v23 op_sel:[1,0,0,0]
    v_mad_u32_u16 v54, v54, s78, v24 op_sel:[1,0,0,0]
    v_mad_u32_u16 v55, v55, s78, v25 op_sel:[1,0,0,0]
    s_add_u32 m0, s67, 4096
    s_nop 0
    buffer_load_dwordx4 v52, s[4:7], s64 offen offset:0 lds
    buffer_load_dwordx4 v53, s[4:7], s64 offen offset:1024 lds
    buffer_load_dwordx4 v54, s[4:7], s64 offen offset:2048 lds
    buffer_load_dwordx4 v55, s[4:7], s64 offen offset:3072 lds
    ds_read2_b32 v[34:35], v31 offset0:1 offset1:3
    ds_read2_b32 v[36:37], v31 offset0:5 offset1:7
    v_mov_b32 v28, v26
    v_and_b32 v0, 31, v1
    v_lshrrev_b32 v40, 5, v1
    v_lshlrev_b32 v0, 4, v0
    v_lshl_add_u32 v0, v40, 10, v0
    v_add_u32 v0, 98304, v0
    s_waitcnt vmcnt(10)
    ds_read_b128 v[48:51], v39
    ds_read_b64_tr_b16 v[40:41], v28 offset:0
    ds_read_b64_tr_b16 v[42:43], v28 offset:64
    ds_read_b64_tr_b16 v[44:45], v28 offset:128
    ds_read_b64_tr_b16 v[46:47], v28 offset:192
    ds_read_u16_d16_hi v38, v30
    v_add_u32 v30, v30, v29
    s_waitcnt lgkmcnt(0)
    v_mul_f32_dpp v6, v38, v40 row_newbcast:0 row_mask:0xf bank_mask:0xf
    v_mul_f32_dpp v7, v38, v41 row_newbcast:1 row_mask:0xf bank_mask:0xf
    v_cvt_pk_bf16_f32 v2, v6, v7
    v_mul_f32_dpp v8, v38, v42 row_newbcast:2 row_mask:0xf bank_mask:0xf
    v_mul_f32_dpp v9, v38, v43 row_newbcast:3 row_mask:0xf bank_mask:0xf
    v_cvt_pk_bf16_f32 v3, v8, v9
    v_mul_f32_dpp v6, v38, v44 row_newbcast:4 row_mask:0xf bank_mask:0xf
    v_mul_f32_dpp v7, v38, v45 row_newbcast:5 row_mask:0xf bank_mask:0xf
    v_cvt_pk_bf16_f32 v4, v6, v7
    v_mul_f32_dpp v8, v38, v46 row_newbcast:6 row_mask:0xf bank_mask:0xf
    v_mul_f32_dpp v9, v38, v47 row_newbcast:7 row_mask:0xf bank_mask:0xf
    v_cvt_pk_bf16_f32 v5, v8, v9
    v_mul_f32_dpp v40, v38, v40 row_newbcast:8 row_mask:0xf bank_mask:0xf
    v_mul_f32_dpp v41, v38, v41 row_newbcast:9 row_mask:0xf bank_mask:0xf
    v_cvt_pk_bf16_f32 v6, v40, v41
    v_mul_f32_dpp v42, v38, v42 row_newbcast:10 row_mask:0xf bank_mask:0xf
    v_mul_f32_dpp v43, v38, v43 row_newbcast:11 row_mask:0xf bank_mask:0xf
    v_cvt_pk_bf16_f32 v7, v42, v43
    v_mul_f32_dpp v44, v38, v44 row_newbcast:12 row_mask:0xf bank_mask:0xf
    v_mul_f32_dpp v45, v38, v45 row_newbcast:13 row_mask:0xf bank_mask:0xf
    v_cvt_pk_bf16_f32 v8, v44, v45
    v_mul_f32_dpp v46, v38, v46 row_newbcast:14 row_mask:0xf bank_mask:0xf
    v_mul_f32_dpp v47, v38, v47 row_newbcast:15 row_mask:0xf bank_mask:0xf
    v_cvt_pk_bf16_f32 v9, v46, v47
    ds_read_b64_tr_b16 v[40:41], v28 offset:512
    ds_read_b64_tr_b16 v[42:43], v28 offset:576
    ds_read_b64_tr_b16 v[44:45], v28 offset:640
    ds_read_b64_tr_b16 v[46:47], v28 offset:704
    ds_read_u16_d16_hi v38, v30
    v_add_u32 v30, v30, v29
    s_branch k2_p1ef
k2_p1ec:
    s_waitcnt vmcnt(5)
    ds_read_b64_tr_b16 v[52:53], v18 offset:0
    ds_read_b64_tr_b16 v[54:55], v18 offset:256
    ds_read_b64_tr_b16 v[56:57], v19 offset:0
    ds_read_b64_tr_b16 v[58:59], v19 offset:256
    ds_read_b64_tr_b16 v[60:61], v20 offset:0
    ds_read_b64_tr_b16 v[62:63], v20 offset:256
    ds_read_b64_tr_b16 v[64:65], v21 offset:0
    ds_read_b64_tr_b16 v[66:67], v21 offset:256
    s_waitcnt lgkmcnt(8)
    v_mad_u32_u16 v34, v34, s78, v22 op_sel:[1,0,0,0]
    v_mad_u32_u16 v35, v35, s78, v23 op_sel:[1,0,0,0]
    v_mad_u32_u16 v36, v36, s78, v24 op_sel:[1,0,0,0]
    v_mad_u32_u16 v37, v37, s78, v25 op_sel:[1,0,0,0]
    v_and_or_b32 v33, v22, 16, v33
    v_mul_f32_dpp v14, v38, v40 row_newbcast:0 row_mask:0xf bank_mask:0xf
    v_mul_f32_dpp v15, v38, v41 row_newbcast:1 row_mask:0xf bank_mask:0xf
    v_cvt_pk_bf16_f32 v10, v14, v15
    v_mul_f32_dpp v16, v38, v42 row_newbcast:2 row_mask:0xf bank_mask:0xf
    v_mul_f32_dpp v17, v38, v43 row_newbcast:3 row_mask:0xf bank_mask:0xf
    v_cvt_pk_bf16_f32 v11, v16, v17
    v_mul_f32_dpp v14, v38, v44 row_newbcast:4 row_mask:0xf bank_mask:0xf
    v_mul_f32_dpp v15, v38, v45 row_newbcast:5 row_mask:0xf bank_mask:0xf
    v_cvt_pk_bf16_f32 v12, v14, v15
    v_mul_f32_dpp v16, v38, v46 row_newbcast:6 row_mask:0xf bank_mask:0xf
    v_mul_f32_dpp v17, v38, v47 row_newbcast:7 row_mask:0xf bank_mask:0xf
    v_cvt_pk_bf16_f32 v13, v16, v17
    s_waitcnt lgkmcnt(6)
    v_mfma_f32_32x32x16_bf16 v[128:143], v[2:5], v[52:55], v[128:143]
    s_add_u32 m0, s67, 0
    v_mul_f32_dpp v40, v38, v40 row_newbcast:8 row_mask:0xf bank_mask:0xf
    v_mul_f32_dpp v41, v38, v41 row_newbcast:9 row_mask:0xf bank_mask:0xf
    v_cvt_pk_bf16_f32 v14, v40, v41
    v_mfma_f32_32x32x16_bf16 v[192:207], v[6:9], v[52:55], v[192:207]
    s_waitcnt lgkmcnt(0)
    buffer_load_dwordx4 v34, s[4:7], s64 offen offset:0 lds
    v_mul_f32_dpp v42, v38, v42 row_newbcast:10 row_mask:0xf bank_mask:0xf
    v_mul_f32_dpp v43, v38, v43 row_newbcast:11 row_mask:0xf bank_mask:0xf
    v_cvt_pk_bf16_f32 v15, v42, v43
    v_mfma_f32_32x32x16_bf16 v[144:159], v[2:5], v[56:59], v[144:159]
    buffer_load_dwordx4 v35, s[4:7], s64 offen offset:1024 lds
    v_mul_f32_dpp v44, v38, v44 row_newbcast:12 row_mask:0xf bank_mask:0xf
    v_mul_f32_dpp v45, v38, v45 row_newbcast:13 row_mask:0xf bank_mask:0xf
    v_cvt_pk_bf16_f32 v16, v44, v45
    v_mfma_f32_32x32x16_bf16 v[208:223], v[6:9], v[56:59], v[208:223]
    buffer_load_dwordx4 v36, s[4:7], s64 offen offset:2048 lds
    v_mul_f32_dpp v46, v38, v46 row_newbcast:14 row_mask:0xf bank_mask:0xf
    v_mul_f32_dpp v47, v38, v47 row_newbcast:15 row_mask:0xf bank_mask:0xf
    v_cvt_pk_bf16_f32 v17, v46, v47
    v_mfma_f32_32x32x16_bf16 v[160:175], v[2:5], v[60:63], v[160:175]
    buffer_load_dwordx4 v37, s[4:7], s64 offen offset:3072 lds
    s_and_b32 s74, s69, 3
    s_lshl_b32 s74, s74, 10
    s_add_u32 s74, s74, s68
    s_cmp_lt_u32 s69, s25
    s_cselect_b32 s10, s10, 0
    s_cselect_b32 m0, s74, 161792
    v_mfma_f32_32x32x16_bf16 v[224:239], v[6:9], v[60:63], v[224:239]
    s_add_u32 s69, s69, 1
    buffer_load_dwordx4 v33, s[8:11], 0 offen  lds
    s_cmp_ge_u32 s70, s71
    s_cbranch_scc1 k2_p1ec_st
    s_lshl_b32 s74, s70, 2
    s_set_gpr_idx_on s74, gpr_idx(DST)
    v_mov_b32 v88, v48
    v_mov_b32 v89, v49
    v_mov_b32 v90, v50
    v_mov_b32 v91, v51
    s_set_gpr_idx_off
k2_p1ec_st:
    v_mfma_f32_32x32x16_bf16 v[176:191], v[2:5], v[64:67], v[176:191]
    s_add_u32 s70, s70, 1
    s_and_b32 s74, s70, 3
    s_lshl_b32 s74, s74, 10
    v_and_or_b32 v28, s74, v27, v26
    ds_read2_b32 v[34:35], v31 offset0:33 offset1:35
    ds_read2_b32 v[36:37], v31 offset0:37 offset1:39
    v_mfma_f32_32x32x16_bf16 v[240:255], v[6:9], v[64:67], v[240:255]
    ds_read_b64_tr_b16 v[40:41], v28 offset:0
    ds_read_b64_tr_b16 v[42:43], v28 offset:64
    ds_read_b64_tr_b16 v[44:45], v28 offset:128
    ds_read_b64_tr_b16 v[46:47], v28 offset:192
    ds_read_u16_d16_hi v38, v30
    v_add_u32 v30, v30, v29
    s_sub_u32 s26, s26, 1
    s_cbranch_scc1 k2_epi1e
k2_p1oc:
    s_waitcnt vmcnt(5)
    ds_read_b64_tr_b16 v[52:53], v18 offset:4096
    ds_read_b64_tr_b16 v[54:55], v18 offset:4352
    ds_read_b64_tr_b16 v[56:57], v19 offset:4096
    ds_read_b64_tr_b16 v[58:59], v19 offset:4352
    ds_read_b64_tr_b16 v[60:61], v20 offset:4096
    ds_read_b64_tr_b16 v[62:63], v20 offset:4352
    ds_read_b64_tr_b16 v[64:65], v21 offset:4096
    ds_read_b64_tr_b16 v[66:67], v21 offset:4352
    s_waitcnt lgkmcnt(8)
    v_mad_u32_u16 v34, v34, s78, v22 op_sel:[1,0,0,0]
    v_mad_u32_u16 v35, v35, s78, v23 op_sel:[1,0,0,0]
    v_mad_u32_u16 v36, v36, s78, v24 op_sel:[1,0,0,0]
    v_mad_u32_u16 v37, v37, s78, v25 op_sel:[1,0,0,0]
    v_mul_f32_dpp v6, v38, v40 row_newbcast:0 row_mask:0xf bank_mask:0xf
    v_mul_f32_dpp v7, v38, v41 row_newbcast:1 row_mask:0xf bank_mask:0xf
    v_cvt_pk_bf16_f32 v2, v6, v7
    v_mul_f32_dpp v8, v38, v42 row_newbcast:2 row_mask:0xf bank_mask:0xf
    v_mul_f32_dpp v9, v38, v43 row_newbcast:3 row_mask:0xf bank_mask:0xf
    v_cvt_pk_bf16_f32 v3, v8, v9
    v_mul_f32_dpp v6, v38, v44 row_newbcast:4 row_mask:0xf bank_mask:0xf
    v_mul_f32_dpp v7, v38, v45 row_newbcast:5 row_mask:0xf bank_mask:0xf
    v_cvt_pk_bf16_f32 v4, v6, v7
    v_mul_f32_dpp v8, v38, v46 row_newbcast:6 row_mask:0xf bank_mask:0xf
    v_mul_f32_dpp v9, v38, v47 row_newbcast:7 row_mask:0xf bank_mask:0xf
    v_cvt_pk_bf16_f32 v5, v8, v9
    s_waitcnt lgkmcnt(6)
    v_mfma_f32_32x32x16_bf16 v[128:143], v[10:13], v[52:55], v[128:143]
    s_add_u32 m0, s67, 4096
    v_mul_f32_dpp v40, v38, v40 row_newbcast:8 row_mask:0xf bank_mask:0xf
    v_mul_f32_dpp v41, v38, v41 row_newbcast:9 row_mask:0xf bank_mask:0xf
    v_cvt_pk_bf16_f32 v6, v40, v41
    v_mfma_f32_32x32x16_bf16 v[192:207], v[14:17], v[52:55], v[192:207]
    s_waitcnt lgkmcnt(0)
    buffer_load_dwordx4 v34, s[4:7], s64 offen offset:0 lds
    v_mul_f32_dpp v42, v38, v42 row_newbcast:10 row_mask:0xf bank_mask:0xf
    v_mul_f32_dpp v43, v38, v43 row_newbcast:11 row_mask:0xf bank_mask:0xf
    v_cvt_pk_bf16_f32 v7, v42, v43
    v_mfma_f32_32x32x16_bf16 v[144:159], v[10:13], v[56:59], v[144:159]
    buffer_load_dwordx4 v35, s[4:7], s64 offen offset:1024 lds
    v_mul_f32_dpp v44, v38, v44 row_newbcast:12 row_mask:0xf bank_mask:0xf
    v_mul_f32_dpp v45, v38, v45 row_newbcast:13 row_mask:0xf bank_mask:0xf
    v_cvt_pk_bf16_f32 v8, v44, v45
    v_mfma_f32_32x32x16_bf16 v[208:223], v[14:17], v[56:59], v[208:223]
    buffer_load_dwordx4 v36, s[4:7], s64 offen offset:2048 lds
    v_mul_f32_dpp v46, v38, v46 row_newbcast:14 row_mask:0xf bank_mask:0xf
    v_mul_f32_dpp v47, v38, v47 row_newbcast:15 row_mask:0xf bank_mask:0xf
    v_cvt_pk_bf16_f32 v9, v46, v47
    v_mfma_f32_32x32x16_bf16 v[160:175], v[10:13], v[60:63], v[160:175]
    buffer_load_dwordx4 v37, s[4:7], s64 offen offset:3072 lds
    s_cmp_eq_u32 s27, 0
    s_cselect_b32 s65, s66, 0x100
    s_cselect_b32 s64, 256, s64
    s_cselect_b32 s74, s24, 0
    s_add_u32 s27, s27, s74
    s_sub_u32 s27, s27, 2
    v_add_u32 v31, s65, v31
    v_mfma_f32_32x32x16_bf16 v[224:239], v[14:17], v[60:63], v[224:239]
    s_and_b32 s74, s70, 3
    s_lshl_b32 s74, s74, 10
    v_or_b32 v33, s74, v39
    ds_read_b128 v[48:51], v33
    ds_read_b32 v33, v32
    v_add_u32 v32, 0x80, v32
    ds_read2_b32 v[34:35], v31 offset0:1 offset1:3
    ds_read2_b32 v[36:37], v31 offset0:5 offset1:7
    v_mfma_f32_32x32x16_bf16 v[176:191], v[10:13], v[64:67], v[176:191]
    ds_read_b64_tr_b16 v[40:41], v28 offset:512
    ds_read_b64_tr_b16 v[42:43], v28 offset:576
    ds_read_b64_tr_b16 v[44:45], v28 offset:640
    ds_read_b64_tr_b16 v[46:47], v28 offset:704
    ds_read_u16_d16_hi v38, v30
    v_add_u32 v30, v30, v29
    v_mfma_f32_32x32x16_bf16 v[240:255], v[14:17], v[64:67], v[240:255]
    s_sub_u32 s26, s26, 1
    s_cbranch_scc1 k2_epi1o
    s_branch k2_p1ec
k2_p1ef:
    s_setprio 2
    s_bitcmp1_b32 s34, s72
    s_cbranch_scc0 k2_p1ef_pr
    s_setprio 3
k2_p1ef_pr:
    s_waitcnt vmcnt(5)
    ds_read_b64_tr_b16 v[52:53], v18 offset:0
    ds_read_b64_tr_b16 v[54:55], v18 offset:256
    ds_read_b64_tr_b16 v[56:57], v19 offset:0
    ds_read_b64_tr_b16 v[58:59], v19 offset:256
    ds_read_b64_tr_b16 v[60:61], v20 offset:0
    ds_read_b64_tr_b16 v[62:63], v20 offset:256
    ds_read_b64_tr_b16 v[64:65], v21 offset:0
    ds_read_b64_tr_b16 v[66:67], v21 offset:256
    s_waitcnt lgkmcnt(8)
    v_mad_u32_u16 v34, v34, s78, v22 op_sel:[1,0,0,0]
    v_mad_u32_u16 v35, v35, s78, v23 op_sel:[1,0,0,0]
    v_mad_u32_u16 v36, v36, s78, v24 op_sel:[1,0,0,0]
    v_mad_u32_u16 v37, v37, s78, v25 op_sel:[1,0,0,0]
    v_and_or_b32 v33, v22, 16, v33
    v_mul_f32_dpp v14, v38, v40 row_newbcast:0 row_mask:0xf bank_mask:0xf
    v_mul_f32_dpp v15, v38, v41 row_newbcast:1 row_mask:0xf bank_mask:0xf
    v_cvt_pk_bf16_f32 v10, v14, v15
    v_mul_f32_dpp v16, v38, v42 row_newbcast:2 row_mask:0xf bank_mask:0xf
    v_mul_f32_dpp v17, v38, v43 row_newbcast:3 row_mask:0xf bank_mask:0xf
    v_cvt_pk_bf16_f32 v11, v16, v17
    v_mul_f32_dpp v14, v38, v44 row_newbcast:4 row_mask:0xf bank_mask:0xf
    v_mul_f32_dpp v15, v38, v45 row_newbcast:5 row_mask:0xf bank_mask:0xf
    v_cvt_pk_bf16_f32 v12, v14, v15
    v_mul_f32_dpp v16, v38, v46 row_newbcast:6 row_mask:0xf bank_mask:0xf
    v_mul_f32_dpp v17, v38, v47 row_newbcast:7 row_mask:0xf bank_mask:0xf
    v_cvt_pk_bf16_f32 v13, v16, v17
    s_waitcnt lgkmcnt(6)
    v_mfma_f32_32x32x16_bf16 v[128:143], v[2:5], v[52:55], 0
    s_add_u32 m0, s67, 0
    v_mul_f32_dpp v40, v38, v40 row_newbcast:8 row_mask:0xf bank_mask:0xf
    v_mul_f32_dpp v41, v38, v41 row_newbcast:9 row_mask:0xf bank_mask:0xf
    v_cvt_pk_bf16_f32 v14, v40, v41
    v_mfma_f32_32x32x16_bf16 v[192:207], v[6:9], v[52:55], 0
    s_waitcnt lgkmcnt(0)
    buffer_load_dwordx4 v34, s[4:7], s64 offen offset:0 lds
    v_mul_f32_dpp v42, v38, v42 row_newbcast:10 row_mask:0xf bank_mask:0xf
    v_mul_f32_dpp v43, v38, v43 row_newbcast:11 row_mask:0xf bank_mask:0xf
    v_cvt_pk_bf16_f32 v15, v42, v43
    v_mfma_f32_32x32x16_bf16 v[144:159], v[2:5], v[56:59], 0
    buffer_load_dwordx4 v35, s[4:7], s64 offen offset:1024 lds
    v_mul_f32_dpp v44, v38, v44 row_newbcast:12 row_mask:0xf bank_mask:0xf
    v_mul_f32_dpp v45, v38, v45 row_newbcast:13 row_mask:0xf bank_mask:0xf
    v_cvt_pk_bf16_f32 v16, v44, v45
    v_mfma_f32_32x32x16_bf16 v[208:223], v[6:9], v[56:59], 0
    buffer_load_dwordx4 v36, s[4:7], s64 offen offset:2048 lds
    v_mul_f32_dpp v46, v38, v46 row_newbcast:14 row_mask:0xf bank_mask:0xf
    v_mul_f32_dpp v47, v38, v47 row_newbcast:15 row_mask:0xf bank_mask:0xf
    v_cvt_pk_bf16_f32 v17, v46, v47
    v_mfma_f32_32x32x16_bf16 v[160:175], v[2:5], v[60:63], 0
    buffer_load_dwordx4 v37, s[4:7], s64 offen offset:3072 lds
    s_and_b32 s74, s69, 3
    s_lshl_b32 s74, s74, 10
    s_add_u32 s74, s74, s68
    s_cmp_lt_u32 s69, s25
    s_cselect_b32 s10, s10, 0
    s_cselect_b32 m0, s74, 161792
    v_mfma_f32_32x32x16_bf16 v[224:239], v[6:9], v[60:63], 0
    s_add_u32 s69, s69, 1
    buffer_load_dwordx4 v33, s[8:11], 0 offen  lds
    s_cmp_ge_u32 s70, s71
    s_cbranch_scc1 k2_p1ef_st
    s_lshl_b32 s74, s70, 2
    s_set_gpr_idx_on s74, gpr_idx(DST)
    v_mov_b32 v88, v48
    v_mov_b32 v89, v49
    v_mov_b32 v90, v50
    v_mov_b32 v91, v51
    s_set_gpr_idx_off
k2_p1ef_st:
    v_mfma_f32_32x32x16_bf16 v[176:191], v[2:5], v[64:67], 0
    s_add_u32 s70, s70, 1
    s_and_b32 s74, s70, 3
    s_lshl_b32 s74, s74, 10
    v_and_or_b32 v28, s74, v27, v26
    ds_read2_b32 v[34:35], v31 offset0:33 offset1:35
    ds_read2_b32 v[36:37], v31 offset0:37 offset1:39
    v_mfma_f32_32x32x16_bf16 v[240:255], v[6:9], v[64:67], 0
    ds_read_b64_tr_b16 v[40:41], v28 offset:0
    ds_read_b64_tr_b16 v[42:43], v28 offset:64
    ds_read_b64_tr_b16 v[44:45], v28 offset:128
    ds_read_b64_tr_b16 v[46:47], v28 offset:192
    ds_read_u16_d16_hi v38, v30
    v_add_u32 v30, v30, v29
    s_sub_u32 s26, s26, 1
    s_cbranch_scc1 k2_epi1e
    s_branch k2_p1oc
k2_p1of:
    s_setprio 2
    s_bitcmp1_b32 s34, s72
    s_cbranch_scc0 k2_p1of_pr
    s_setprio 3
k2_p1of_pr:
    s_waitcnt vmcnt(5)
    ds_read_b64_tr_b16 v[52:53], v18 offset:4096
    ds_read_b64_tr_b16 v[54:55], v18 offset:4352
    ds_read_b64_tr_b16 v[56:57], v19 offset:4096
    ds_read_b64_tr_b16 v[58:59], v19 offset:4352
    ds_read_b64_tr_b16 v[60:61], v20 offset:4096
    ds_read_b64_tr_b16 v[62:63], v20 offset:4352
    ds_read_b64_tr_b16 v[64:65], v21 offset:4096
    ds_read_b64_tr_b16 v[66:67], v21 offset:4352
    s_waitcnt lgkmcnt(8)
    v_mad_u32_u16 v34, v34, s78, v22 op_sel:[1,0,0,0]
    v_mad_u32_u16 v35, v35, s78, v23 op_sel:[1,0,0,0]
    v_mad_u32_u16 v36, v36, s78, v24 op_sel:[1,0,0,0]
    v_mad_u32_u16 v37, v37, s78, v25 op_sel:[1,0,0,0]
    v_mul_f32_dpp v6, v38, v40 row_newbcast:0 row_mask:0xf bank_mask:0xf
    v_mul_f32_dpp v7, v38, v41 row_newbcast:1 row_mask:0xf bank_mask:0xf
    v_cvt_pk_bf16_f32 v2, v6, v7
    v_mul_f32_dpp v8, v38, v42 row_newbcast:2 row_mask:0xf bank_mask:0xf
    v_mul_f32_dpp v9, v38, v43 row_newbcast:3 row_mask:0xf bank_mask:0xf
    v_cvt_pk_bf16_f32 v3, v8, v9
    v_mul_f32_dpp v6, v38, v44 row_newbcast:4 row_mask:0xf bank_mask:0xf
    v_mul_f32_dpp v7, v38, v45 row_newbcast:5 row_mask:0xf bank_mask:0xf
    v_cvt_pk_bf16_f32 v4, v6, v7
    v_mul_f32_dpp v8, v38, v46 row_newbcast:6 row_mask:0xf bank_mask:0xf
    v_mul_f32_dpp v9, v38, v47 row_newbcast:7 row_mask:0xf bank_mask:0xf
    v_cvt_pk_bf16_f32 v5, v8, v9
    s_waitcnt lgkmcnt(6)
    v_mfma_f32_32x32x16_bf16 v[128:143], v[10:13], v[52:55], 0
    s_add_u32 m0, s67, 4096
    v_mul_f32_dpp v40, v38, v40 row_newbcast:8 row_mask:0xf bank_mask:0xf
    v_mul_f32_dpp v41, v38, v41 row_newbcast:9 row_mask:0xf bank_mask:0xf
    v_cvt_pk_bf16_f32 v6, v40, v41
    v_mfma_f32_32x32x16_bf16 v[192:207], v[14:17], v[52:55], 0
    s_waitcnt lgkmcnt(0)
    buffer_load_dwordx4 v34, s[4:7], s64 offen offset:0 lds
    v_mul_f32_dpp v42, v38, v42 row_newbcast:10 row_mask:0xf bank_mask:0xf
    v_mul_f32_dpp v43, v38, v43 row_newbcast:11 row_mask:0xf bank_mask:0xf
    v_cvt_pk_bf16_f32 v7, v42, v43
    v_mfma_f32_32x32x16_bf16 v[144:159], v[10:13], v[56:59], 0
    buffer_load_dwordx4 v35, s[4:7], s64 offen offset:1024 lds
    v_mul_f32_dpp v44, v38, v44 row_newbcast:12 row_mask:0xf bank_mask:0xf
    v_mul_f32_dpp v45, v38, v45 row_newbcast:13 row_mask:0xf bank_mask:0xf
    v_cvt_pk_bf16_f32 v8, v44, v45
    v_mfma_f32_32x32x16_bf16 v[208:223], v[14:17], v[56:59], 0
    buffer_load_dwordx4 v36, s[4:7], s64 offen offset:2048 lds
    v_mul_f32_dpp v46, v38, v46 row_newbcast:14 row_mask:0xf bank_mask:0xf
    v_mul_f32_dpp v47, v38, v47 row_newbcast:15 row_mask:0xf bank_mask:0xf
    v_cvt_pk_bf16_f32 v9, v46, v47
    v_mfma_f32_32x32x16_bf16 v[160:175], v[10:13], v[60:63], 0
    buffer_load_dwordx4 v37, s[4:7], s64 offen offset:3072 lds
    s_cmp_eq_u32 s27, 0
    s_cselect_b32 s65, s66, 0x100
    s_cselect_b32 s64, 256, s64
    s_cselect_b32 s74, s24, 0
    s_add_u32 s27, s27, s74
    s_sub_u32 s27, s27, 2
    v_add_u32 v31, s65, v31
    v_mfma_f32_32x32x16_bf16 v[224:239], v[14:17], v[60:63], 0
    s_and_b32 s74, s70, 3
    s_lshl_b32 s74, s74, 10
    v_or_b32 v33, s74, v39
    ds_read_b128 v[48:51], v33
    ds_read_b32 v33, v32
    v_add_u32 v32, 0x80, v32
    ds_read2_b32 v[34:35], v31 offset0:1 offset1:3
    ds_read2_b32 v[36:37], v31 offset0:5 offset1:7
    v_mfma_f32_32x32x16_bf16 v[176:191], v[10:13], v[64:67], 0
    ds_read_b64_tr_b16 v[40:41], v28 offset:512
    ds_read_b64_tr_b16 v[42:43], v28 offset:576
    ds_read_b64_tr_b16 v[44:45], v28 offset:640
    ds_read_b64_tr_b16 v[46:47], v28 offset:704
    ds_read_u16_d16_hi v38, v30
    v_add_u32 v30, v30, v29
    v_mfma_f32_32x32x16_bf16 v[240:255], v[14:17], v[64:67], 0
    s_sub_u32 s26, s26, 1
    s_cbranch_scc1 k2_epi1o
    s_branch k2_p1ec
k2_epi1e:
    s_setprio 0
    ds_read_b128 v[52:55], v0 offset:8192
    ds_read_b128 v[56:59], v0 offset:10240
    ds_read_b128 v[60:63], v0 offset:8704
    ds_read_b128 v[64:67], v0 offset:10752
    ds_read_b128 v[2:5], v0 offset:0
    ds_read_b128 v[6:9], v0 offset:2048
    s_waitcnt lgkmcnt(4)
    v_pk_mul_f32 v[136:137], v[136:137], v[52:53]
    v_pk_mul_f32 v[192:193], v[192:193], v[52:53]
    v_pk_mul_f32 v[200:201], v[200:201], v[52:53]
    v_pk_fma_f32 v[136:137], v[138:139], v[54:55], v[136:137]
    v_pk_fma_f32 v[192:193], v[194:195], v[54:55], v[192:193]
    v_pk_fma_f32 v[200:201], v[202:203], v[54:55], v[200:201]
    v_pk_fma_f32 v[136:137], v[140:141], v[56:57], v[136:137]
    v_pk_fma_f32 v[192:193], v[196:197], v[56:57], v[192:193]
    v_pk_fma_f32 v[200:201], v[204:205], v[56:57], v[200:201]
    v_pk_fma_f32 v[136:137], v[142:143], v[58:59], v[136:137]
    v_pk_fma_f32 v[192:193], v[198:199], v[58:59], v[192:193]
    v_pk_fma_f32 v[200:201], v[206:207], v[58:59], v[200:201]
    ds_read_b128 v[52:55], v0 offset:512
    ds_read_b128 v[56:59], v0 offset:2560
    s_waitcnt lgkmcnt(4)
    v_pk_mul_f32 v[138:139], v[152:153], v[60:61]
    v_pk_mul_f32 v[194:195], v[208:209], v[60:61]
    v_pk_mul_f32 v[202:203], v[216:217], v[60:61]
    v_pk_fma_f32 v[138:139], v[154:155], v[62:63], v[138:139]
    v_pk_fma_f32 v[194:195], v[210:211], v[62:63], v[194:195]
    v_pk_fma_f32 v[202:203], v[218:219], v[62:63], v[202:203]
    v_pk_fma_f32 v[138:139], v[156:157], v[64:65], v[138:139]
    v_pk_fma_f32 v[194:195], v[212:213], v[64:65], v[194:195]
    v_pk_fma_f32 v[202:203], v[220:221], v[64:65], v[202:203]
    v_pk_fma_f32 v[138:139], v[158:159], v[66:67], v[138:139]
    v_pk_fma_f32 v[194:195], v[214:215], v[66:67], v[194:195]
    v_pk_fma_f32 v[202:203], v[222:223], v[66:67], v[202:203]
    ds_read_b128 v[152:155], v0 offset:16384
    ds_read_b128 v[156:159], v0 offset:18432
    ds_read_b128 v[208:211], v0 offset:16896
    ds_read_b128 v[212:215], v0 offset:18944
    ds_read_b128 v[216:219], v0 offset:12288
    ds_read_b128 v[220:223], v0 offset:14336
    ds_read_b128 v[60:63], v0 offset:12800
    ds_read_b128 v[64:67], v0 offset:14848
    s_waitcnt lgkmcnt(10)
    v_pk_mul_f32 v[128:129], v[128:129], v[2:3]
    v_pk_fma_f32 v[128:129], v[130:131], v[4:5], v[128:129]
    v_pk_fma_f32 v[128:129], v[132:133], v[6:7], v[128:129]
    v_pk_fma_f32 v[128:129], v[134:135], v[8:9], v[128:129]
    ds_read_b128 v[2:5], v0 offset:4096
    ds_read_b128 v[6:9], v0 offset:6144
    s_waitcnt lgkmcnt(10)
    v_pk_mul_f32 v[130:131], v[144:145], v[52:53]
    v_pk_fma_f32 v[130:131], v[146:147], v[54:55], v[130:131]
    v_pk_fma_f32 v[130:131], v[148:149], v[56:57], v[130:131]
    v_pk_fma_f32 v[130:131], v[150:151], v[58:59], v[130:131]
    ds_read_b128 v[144:147], v0 offset:4608
    ds_read_b128 v[148:151], v0 offset:6656
    s_waitcnt lgkmcnt(10)
    v_pk_mul_f32 v[224:225], v[224:225], v[152:153] neg_lo:[1,0] neg_hi:[1,0]
    v_pk_mul_f32 v[232:233], v[232:233], v[152:153]
    v_pk_fma_f32 v[224:225], v[226:227], v[154:155], v[224:225] neg_lo:[1,0,0] neg_hi:[1,0,0]
    v_pk_fma_f32 v[232:233], v[234:235], v[154:155], v[232:233]
    v_pk_fma_f32 v[224:225], v[228:229], v[156:157], v[224:225] neg_lo:[1,0,0] neg_hi:[1,0,0]
    v_pk_fma_f32 v[232:233], v[236:237], v[156:157], v[232:233]
    v_pk_fma_f32 v[224:225], v[230:231], v[158:159], v[224:225] neg_lo:[1,0,0] neg_hi:[1,0,0]
    v_pk_fma_f32 v[232:233], v[238:239], v[158:159], v[232:233]
    s_waitcnt lgkmcnt(8)
    v_pk_mul_f32 v[226:227], v[240:241], v[208:209] neg_lo:[1,0] neg_hi:[1,0]
    v_pk_mul_f32 v[234:235], v[248:249], v[208:209]
    v_pk_fma_f32 v[226:227], v[242:243], v[210:211], v[226:227] neg_lo:[1,0,0] neg_hi:[1,0,0]
    v_pk_fma_f32 v[234:235], v[250:251], v[210:211], v[234:235]
    v_pk_fma_f32 v[226:227], v[244:245], v[212:213], v[226:227] neg_lo:[1,0,0] neg_hi:[1,0,0]
    v_pk_fma_f32 v[234:235], v[252:253], v[212:213], v[234:235]
    v_pk_fma_f32 v[226:227], v[246:247], v[214:215], v[226:227] neg_lo:[1,0,0] neg_hi:[1,0,0]
    v_pk_fma_f32 v[234:235], v[254:255], v[214:215], v[234:235]
    s_waitcnt lgkmcnt(6)
    v_pk_mul_f32 v[160:161], v[160:161], v[216:217]
    v_pk_fma_f32 v[160:161], v[162:163], v[218:219], v[160:161]
    v_pk_fma_f32 v[160:161], v[164:165], v[220:221], v[160:161]
    v_pk_fma_f32 v[160:161], v[166:167], v[222:223], v[160:161]
    s_waitcnt lgkmcnt(4)
    v_pk_mul_f32 v[162:163], v[176:177], v[60:61]
    v_pk_fma_f32 v[162:163], v[178:179], v[62:63], v[162:163]
    v_pk_fma_f32 v[162:163], v[180:181], v[64:65], v[162:163]
    v_pk_fma_f32 v[162:163], v[182:183], v[66:67], v[162:163]
    s_waitcnt lgkmcnt(2)
    v_pk_mul_f32 v[168:169], v[168:169], v[2:3]
    v_pk_fma_f32 v[168:169], v[170:171], v[4:5], v[168:169]
    v_pk_fma_f32 v[168:169], v[172:173], v[6:7], v[168:169]
    v_pk_fma_f32 v[168:169], v[174:175], v[8:9], v[168:169]
    s_waitcnt lgkmcnt(0)
    v_pk_mul_f32 v[170:171], v[184:185], v[144:145]
    v_pk_fma_f32 v[170:171], v[186:187], v[146:147], v[170:171]
    v_pk_fma_f32 v[170:171], v[188:189], v[148:149], v[170:171]
    v_pk_fma_f32 v[170:171], v[190:191], v[150:151], v[170:171]
    v_add_f32 v136, v136, v137
    v_add_f32 v138, v138, v139
    v_add_f32 v192, v192, v193
    v_add_f32 v194, v194, v195
    v_add_f32 v200, v200, v201
    v_add_f32 v202, v202, v203
    v_add_f32 v128, v128, v129
    v_add_f32 v130, v130, v131
    v_add_f32 v224, v224, v225
    v_add_f32 v226, v226, v227
    v_add_f32 v232, v232, v233
    v_add_f32 v234, v234, v235
    v_add_f32 v160, v160, v161
    v_add_f32 v162, v162, v163
    v_add_f32 v168, v168, v169
    v_add_f32 v170, v170, v171
    v_permlane32_swap_b32 v136, v138
    v_permlane32_swap_b32 v192, v194
    v_permlane32_swap_b32 v200, v202
    v_permlane32_swap_b32 v128, v130
    v_permlane32_swap_b32 v224, v226
    v_permlane32_swap_b32 v232, v234
    v_permlane32_swap_b32 v160, v162
    v_permlane32_swap_b32 v168, v170
    v_add_f32 v136, v136, v138
    v_add_f32 v192, v192, v194
    v_add_f32 v200, v200, v202
    v_add_f32 v128, v128, v130
    v_add_f32 v224, v224, v226
    v_add_f32 v232, v232, v234
    v_add_f32 v160, v160, v162
    v_add_f32 v168, v168, v170
    s_lshr_b64 s[30:31], s[30:31], 12
    s_set_gpr_idx_on s72, gpr_idx(DST)
    v_cvt_pk_bf16_f32 v68, v128, v168
    v_cvt_pk_bf16_f32 v69, v136, v160
    v_cvt_pk_bf16_f32 v70, v192, v232
    v_cvt_pk_bf16_f32 v71, v200, v224
    s_set_gpr_idx_off
    s_add_u32 s72, s72, 4
    s_and_b32 s26, s30, 0xfff
    s_branch k2_p1of
k2_epi1o:
    s_setprio 0
    ds_read_b128 v[52:55], v0 offset:8192
    ds_read_b128 v[56:59], v0 offset:10240
    ds_read_b128 v[60:63], v0 offset:8704
    ds_read_b128 v[64:67], v0 offset:10752
    ds_read_b128 v[10:13], v0 offset:0
    ds_read_b128 v[14:17], v0 offset:2048
    s_waitcnt lgkmcnt(4)
    v_pk_mul_f32 v[136:137], v[136:137], v[52:53]
    v_pk_mul_f32 v[192:193], v[192:193], v[52:53]
    v_pk_mul_f32 v[200:201], v[200:201], v[52:53]
    v_pk_fma_f32 v[136:137], v[138:139], v[54:55], v[136:137]
    v_pk_fma_f32 v[192:193], v[194:195], v[54:55], v[192:193]
    v_pk_fma_f32 v[200:201], v[202:203], v[54:55], v[200:201]
    v_pk_fma_f32 v[136:137], v[140:141], v[56:57], v[136:137]
    v_pk_fma_f32 v[192:193], v[196:197], v[56:57], v[192:193]
    v_pk_fma_f32 v[200:201], v[204:205], v[56:57], v[200:201]
    v_pk_fma_f32 v[136:137], v[142:143], v[58:59], v[136:137]
    v_pk_fma_f32 v[192:193], v[198:199], v[58:59], v[192:193]
    v_pk_fma_f32 v[200:201], v[206:207], v[58:59], v[200:201]
    ds_read_b128 v[52:55], v0 offset:512
    ds_read_b128 v[56:59], v0 offset:2560
    s_waitcnt lgkmcnt(4)
    v_pk_mul_f32 v[138:139], v[152:153], v[60:61]
    v_pk_mul_f32 v[194:195], v[208:209], v[60:61]
    v_pk_mul_f32 v[202:203], v[216:217], v[60:61]
    v_pk_fma_f32 v[138:139], v[154:155], v[62:63], v[138:139]
    v_pk_fma_f32 v[194:195], v[210:211], v[62:63], v[194:195]
    v_pk_fma_f32 v[202:203], v[218:219], v[62:63], v[202:203]
    v_pk_fma_f32 v[138:139], v[156:157], v[64:65], v[138:139]
    v_pk_fma_f32 v[194:195], v[212:213], v[64:65], v[194:195]
    v_pk_fma_f32 v[202:203], v[220:221], v[64:65], v[202:203]
    v_pk_fma_f32 v[138:139], v[158:159], v[66:67], v[138:139]
    v_pk_fma_f32 v[194:195], v[214:215], v[66:67], v[194:195]
    v_pk_fma_f32 v[202:203], v[222:223], v[66:67], v[202:203]
    ds_read_b128 v[152:155], v0 offset:16384
    ds_read_b128 v[156:159], v0 offset:18432
    ds_read_b128 v[208:211], v0 offset:16896
    ds_read_b128 v[212:215], v0 offset:18944
    ds_read_b128 v[216:219], v0 offset:12288
    ds_read_b128 v[220:223], v0 offset:14336
    ds_read_b128 v[60:63], v0 offset:12800
    ds_read_b128 v[64:67], v0 offset:14848
    s_waitcnt lgkmcnt(10)
    v_pk_mul_f32 v[128:129], v[128:129], v[10:11]
    v_pk_fma_f32 v[128:129], v[130:131], v[12:13], v[128:129]
    v_pk_fma_f32 v[128:129], v[132:133], v[14:15], v[128:129]
    v_pk_fma_f32 v[128:129], v[134:135], v[16:17], v[128:129]
    ds_read_b128 v[10:13], v0 offset:4096
    ds_read_b128 v[14:17], v0 offset:6144
    s_waitcnt lgkmcnt(10)
    v_pk_mul_f32 v[130:131], v[144:145], v[52:53]
    v_pk_fma_f32 v[130:131], v[146:147], v[54:55], v[130:131]
    v_pk_fma_f32 v[130:131], v[148:149], v[56:57], v[130:131]
    v_pk_fma_f32 v[130:131], v[150:151], v[58:59], v[130:131]
    ds_read_b128 v[144:147], v0 offset:4608
    ds_read_b128 v[148:151], v0 offset:6656
    s_waitcnt lgkmcnt(10)
    v_pk_mul_f32 v[224:225], v[224:225], v[152:153] neg_lo:[1,0] neg_hi:[1,0]
    v_pk_mul_f32 v[232:233], v[232:233], v[152:153]
    v_pk_fma_f32 v[224:225], v[226:227], v[154:155], v[224:225] neg_lo:[1,0,0] neg_hi:[1,0,0]
    v_pk_fma_f32 v[232:233], v[234:235], v[154:155], v[232:233]
    v_pk_fma_f32 v[224:225], v[228:229], v[156:157], v[224:225] neg_lo:[1,0,0] neg_hi:[1,0,0]
    v_pk_fma_f32 v[232:233], v[236:237], v[156:157], v[232:233]
    v_pk_fma_f32 v[224:225], v[230:231], v[158:159], v[224:225] neg_lo:[1,0,0] neg_hi:[1,0,0]
    v_pk_fma_f32 v[232:233], v[238:239], v[158:159], v[232:233]
    s_waitcnt lgkmcnt(8)
    v_pk_mul_f32 v[226:227], v[240:241], v[208:209] neg_lo:[1,0] neg_hi:[1,0]
    v_pk_mul_f32 v[234:235], v[248:249], v[208:209]
    v_pk_fma_f32 v[226:227], v[242:243], v[210:211], v[226:227] neg_lo:[1,0,0] neg_hi:[1,0,0]
    v_pk_fma_f32 v[234:235], v[250:251], v[210:211], v[234:235]
    v_pk_fma_f32 v[226:227], v[244:245], v[212:213], v[226:227] neg_lo:[1,0,0] neg_hi:[1,0,0]
    v_pk_fma_f32 v[234:235], v[252:253], v[212:213], v[234:235]
    v_pk_fma_f32 v[226:227], v[246:247], v[214:215], v[226:227] neg_lo:[1,0,0] neg_hi:[1,0,0]
    v_pk_fma_f32 v[234:235], v[254:255], v[214:215], v[234:235]
    s_waitcnt lgkmcnt(6)
    v_pk_mul_f32 v[160:161], v[160:161], v[216:217]
    v_pk_fma_f32 v[160:161], v[162:163], v[218:219], v[160:161]
    v_pk_fma_f32 v[160:161], v[164:165], v[220:221], v[160:161]
    v_pk_fma_f32 v[160:161], v[166:167], v[222:223], v[160:161]
    s_waitcnt lgkmcnt(4)
    v_pk_mul_f32 v[162:163], v[176:177], v[60:61]
    v_pk_fma_f32 v[162:163], v[178:179], v[62:63], v[162:163]
    v_pk_fma_f32 v[162:163], v[180:181], v[64:65], v[162:163]
    v_pk_fma_f32 v[162:163], v[182:183], v[66:67], v[162:163]
    s_waitcnt lgkmcnt(2)
    v_pk_mul_f32 v[168:169], v[168:169], v[10:11]
    v_pk_fma_f32 v[168:169], v[170:171], v[12:13], v[168:169]
    v_pk_fma_f32 v[168:169], v[172:173], v[14:15], v[168:169]
    v_pk_fma_f32 v[168:169], v[174:175], v[16:17], v[168:169]
    s_waitcnt lgkmcnt(0)
    v_pk_mul_f32 v[170:171], v[184:185], v[144:145]
    v_pk_fma_f32 v[170:171], v[186:187], v[146:147], v[170:171]
    v_pk_fma_f32 v[170:171], v[188:189], v[148:149], v[170:171]
    v_pk_fma_f32 v[170:171], v[190:191], v[150:151], v[170:171]
    v_add_f32 v136, v136, v137
    v_add_f32 v138, v138, v139
    v_add_f32 v192, v192, v193
    v_add_f32 v194, v194, v195
    v_add_f32 v200, v200, v201
    v_add_f32 v202, v202, v203
    v_add_f32 v128, v128, v129
    v_add_f32 v130, v130, v131
    v_add_f32 v224, v224, v225
    v_add_f32 v226, v226, v227
    v_add_f32 v232, v232, v233
    v_add_f32 v234, v234, v235
    v_add_f32 v160, v160, v161
    v_add_f32 v162, v162, v163
    v_add_f32 v168, v168, v169
    v_add_f32 v170, v170, v171
    v_permlane32_swap_b32 v136, v138
    v_permlane32_swap_b32 v192, v194
    v_permlane32_swap_b32 v200, v202
    v_permlane32_swap_b32 v128, v130
    v_permlane32_swap_b32 v224, v226
    v_permlane32_swap_b32 v232, v234
    v_permlane32_swap_b32 v160, v162
    v_permlane32_swap_b32 v168, v170
    v_add_f32 v136, v136, v138
    v_add_f32 v192, v192, v194
    v_add_f32 v200, v200, v202
    v_add_f32 v128, v128, v130
    v_add_f32 v224, v224, v226
    v_add_f32 v232, v232, v234
    v_add_f32 v160, v160, v162
    v_add_f32 v168, v168, v170
    s_lshr_b64 s[30:31], s[30:31], 12
    s_set_gpr_idx_on s72, gpr_idx(DST)
    v_cvt_pk_bf16_f32 v68, v128, v168
    v_cvt_pk_bf16_f32 v69, v136, v160
    v_cvt_pk_bf16_f32 v70, v192, v232
    v_cvt_pk_bf16_f32 v71, v200, v224
    s_set_gpr_idx_off
    s_add_u32 s72, s72, 4
    s_and_b32 s26, s30, 0xfff
    s_cmp_eq_u32 s72, s84
    s_cbranch_scc1 k2_p1_end
    s_branch k2_p1ef
k2_p1_end:
    s_cmp_ge_u32 s3, 4
    s_cselect_b32 s34, 69905, 0
    s_mov_b64 s[30:31], s[28:29]
    s_and_b32 s26, s30, 0xfff
    s_mov_b32 s72, 0
    s_mov_b32 s73, 0
    s_mov_b32 s70, 0
    s_waitcnt lgkmcnt(0)
    s_lshl_b32 s74, s81, 3
    s_add_u32 s74, s74, 118782
    v_bfe_u32 v48, v1, 3, 1
    v_bfe_u32 v49, v1, 4, 1
    v_lshl_add_u32 v48, v48, 1, v49
    v_and_b32 v49, 7, v1
    v_lshrrev_b32 v50, 5, v1
    v_lshl_add_u32 v49, v50, 3, v49
    v_lshlrev_b32 v49, 3, v49
    v_lshl_add_u32 v49, v48, 1, v49
    v_add_u32 v49, s74, v49
    v_cmp_eq_u32 vcc, 0, v48
    v_mov_b32 v50, 163824
    v_mov_b32 v51, 0x80
    v_cndmask_b32 v30, v49, v50, vcc
    v_cndmask_b32 v29, v51, 0, vcc
    s_add_u32 s74, s25, 4
    s_lshl_b32 s74, s74, 7
    v_subrev_u32 v32, s74, v32
    s_mov_b32 s10, 20480000
    s_and_b32 s74, s70, 3
    s_lshl_b32 s74, s74, 10
    s_cmp_lt_u32 s70, s80
    s_cselect_b32 s74, s79, s74
    v_and_or_b32 v28, s74, v27, v26
    s_cbranch_scc0 k2_p2_r0_done
    s_cmp_ge_u32 s70, s71
    s_cbranch_scc1 k2_p2_r0_g
    s_lshl_b32 s74, s70, 2
    s_set_gpr_idx_on s74, gpr_idx(SRC0)
    v_mov_b32 v48, v88
    v_mov_b32 v49, v89
    v_mov_b32 v50, v90
    v_mov_b32 v51, v91
    s_set_gpr_idx_off
    v_or_b32 v33, s79, v39
    ds_write_b128 v33, v[48:51]
k2_p2_r0_done:
    ds_read_b64_tr_b16 v[40:41], v28 offset:0
    ds_read_b64_tr_b16 v[42:43], v28 offset:64
    ds_read_b64_tr_b16 v[44:45], v28 offset:128
    ds_read_b64_tr_b16 v[46:47], v28 offset:192
    ds_read_u16_d16_hi v38, v30
    v_add_u32 v30, v30, v29
    s_waitcnt lgkmcnt(0)
    v_mul_f32_dpp v6, v38, v40 row_newbcast:0 row_mask:0xf bank_mask:0xf
    v_mul_f32_dpp v7, v38, v41 row_newbcast:1 row_mask:0xf bank_mask:0xf
    v_cvt_pk_bf16_f32 v2, v6, v7
    v_mul_f32_dpp v8, v38, v42 row_newbcast:2 row_mask:0xf bank_mask:0xf
    v_mul_f32_dpp v9, v38, v43 row_newbcast:3 row_mask:0xf bank_mask:0xf
    v_cvt_pk_bf16_f32 v3, v8, v9
    v_mul_f32_dpp v6, v38, v44 row_newbcast:4 row_mask:0xf bank_mask:0xf
    v_mul_f32_dpp v7, v38, v45 row_newbcast:5 row_mask:0xf bank_mask:0xf
    v_cvt_pk_bf16_f32 v4, v6, v7
    v_mul_f32_dpp v8, v38, v46 row_newbcast:6 row_mask:0xf bank_mask:0xf
    v_mul_f32_dpp v9, v38, v47 row_newbcast:7 row_mask:0xf bank_mask:0xf
    v_cvt_pk_bf16_f32 v5, v8, v9
    v_mul_f32_dpp v40, v38, v40 row_newbcast:8 row_mask:0xf bank_mask:0xf
    v_mul_f32_dpp v41, v38, v41 row_newbcast:9 row_mask:0xf bank_mask:0xf
    v_cvt_pk_bf16_f32 v6, v40, v41
    v_mul_f32_dpp v42, v38, v42 row_newbcast:10 row_mask:0xf bank_mask:0xf
    v_mul_f32_dpp v43, v38, v43 row_newbcast:11 row_mask:0xf bank_mask:0xf
    v_cvt_pk_bf16_f32 v7, v42, v43
    v_mul_f32_dpp v44, v38, v44 row_newbcast:12 row_mask:0xf bank_mask:0xf
    v_mul_f32_dpp v45, v38, v45 row_newbcast:13 row_mask:0xf bank_mask:0xf
    v_cvt_pk_bf16_f32 v8, v44, v45
    v_mul_f32_dpp v46, v38, v46 row_newbcast:14 row_mask:0xf bank_mask:0xf
    v_mul_f32_dpp v47, v38, v47 row_newbcast:15 row_mask:0xf bank_mask:0xf
    v_cvt_pk_bf16_f32 v9, v46, v47
    ds_read_b64_tr_b16 v[40:41], v28 offset:512
    ds_read_b64_tr_b16 v[42:43], v28 offset:576
    ds_read_b64_tr_b16 v[44:45], v28 offset:640
    ds_read_b64_tr_b16 v[46:47], v28 offset:704
    ds_read_u16_d16_hi v38, v30
    v_add_u32 v30, v30, v29
    s_branch k2_p2ef
k2_p2ec:
    s_waitcnt vmcnt(4)
    ds_read_b64_tr_b16 v[52:53], v18 offset:0
    ds_read_b64_tr_b16 v[54:55], v18 offset:256
    ds_read_b64_tr_b16 v[56:57], v19 offset:0
    ds_read_b64_tr_b16 v[58:59], v19 offset:256
    ds_read_b64_tr_b16 v[60:61], v20 offset:0
    ds_read_b64_tr_b16 v[62:63], v20 offset:256
    ds_read_b64_tr_b16 v[64:65], v21 offset:0
    ds_read_b64_tr_b16 v[66:67], v21 offset:256
    s_waitcnt lgkmcnt(8)
    v_mad_u32_u16 v34, v34, s78, v22 op_sel:[1,0,0,0]
    v_mad_u32_u16 v35, v35, s78, v23 op_sel:[1,0,0,0]
    v_mad_u32_u16 v36, v36, s78, v24 op_sel:[1,0,0,0]
    v_mad_u32_u16 v37, v37, s78, v25 op_sel:[1,0,0,0]
    v_mul_f32_dpp v14, v38, v40 row_newbcast:0 row_mask:0xf bank_mask:0xf
    v_mul_f32_dpp v15, v38, v41 row_newbcast:1 row_mask:0xf bank_mask:0xf
    v_cvt_pk_bf16_f32 v10, v14, v15
    v_mul_f32_dpp v16, v38, v42 row_newbcast:2 row_mask:0xf bank_mask:0xf
    v_mul_f32_dpp v17, v38, v43 row_newbcast:3 row_mask:0xf bank_mask:0xf
    v_cvt_pk_bf16_f32 v11, v16, v17
    v_mul_f32_dpp v14, v38, v44 row_newbcast:4 row_mask:0xf bank_mask:0xf
    v_mul_f32_dpp v15, v38, v45 row_newbcast:5 row_mask:0xf bank_mask:0xf
    v_cvt_pk_bf16_f32 v12, v14, v15
    v_mul_f32_dpp v16, v38, v46 row_newbcast:6 row_mask:0xf bank_mask:0xf
    v_mul_f32_dpp v17, v38, v47 row_newbcast:7 row_mask:0xf bank_mask:0xf
    v_cvt_pk_bf16_f32 v13, v16, v17
    s_waitcnt lgkmcnt(6)
    v_mfma_f32_32x32x16_bf16 v[128:143], v[2:5], v[52:55], v[128:143]
    s_add_u32 m0, s67, 0
    v_mul_f32_dpp v40, v38, v40 row_newbcast:8 row_mask:0xf bank_mask:0xf
    v_mul_f32_dpp v41, v38, v41 row_newbcast:9 row_mask:0xf bank_mask:0xf
    v_cvt_pk_bf16_f32 v14, v40, v41
    v_mfma_f32_32x32x16_bf16 v[192:207], v[6:9], v[52:55], v[192:207]
    s_waitcnt lgkmcnt(0)
    buffer_load_dwordx4 v34, s[4:7], s64 offen offset:0 lds
    v_mul_f32_dpp v42, v38, v42 row_newbcast:10 row_mask:0xf bank_mask:0xf
    v_mul_f32_dpp v43, v38, v43 row_newbcast:11 row_mask:0xf bank_mask:0xf
    v_cvt_pk_bf16_f32 v15, v42, v43
    v_mfma_f32_32x32x16_bf16 v[144:159], v[2:5], v[56:59], v[144:159]
    buffer_load_dwordx4 v35, s[4:7], s64 offen offset:1024 lds
    v_mul_f32_dpp v44, v38, v44 row_newbcast:12 row_mask:0xf bank_mask:0xf
    v_mul_f32_dpp v45, v38, v45 row_newbcast:13 row_mask:0xf bank_mask:0xf
    v_cvt_pk_bf16_f32 v16, v44, v45
    v_mfma_f32_32x32x16_bf16 v[208:223], v[6:9], v[56:59], v[208:223]
    buffer_load_dwordx4 v36, s[4:7], s64 offen offset:2048 lds
    v_mul_f32_dpp v46, v38, v46 row_newbcast:14 row_mask:0xf bank_mask:0xf
    v_mul_f32_dpp v47, v38, v47 row_newbcast:15 row_mask:0xf bank_mask:0xf
    v_cvt_pk_bf16_f32 v17, v46, v47
    v_mfma_f32_32x32x16_bf16 v[160:175], v[2:5], v[60:63], v[160:175]
    buffer_load_dwordx4 v37, s[4:7], s64 offen offset:3072 lds
    s_add_u32 s70, s70, 1
    v_mfma_f32_32x32x16_bf16 v[224:239], v[6:9], v[60:63], v[224:239]
    s_and_b32 s74, s70, 3
    s_lshl_b32 s74, s74, 10
    s_cmp_lt_u32 s70, s80
    s_cselect_b32 s74, s79, s74
    v_and_or_b32 v28, s74, v27, v26
    s_cbranch_scc0 k2_p2ec_r_done
    s_cmp_ge_u32 s70, s71
    s_cbranch_scc1 k2_p2ec_r_g
    s_lshl_b32 s74, s70, 2
    s_set_gpr_idx_on s74, gpr_idx(SRC0)
    v_mov_b32 v48, v88
    v_mov_b32 v49, v89
    v_mov_b32 v50, v90
    v_mov_b32 v51, v91
    s_set_gpr_idx_off
    v_or_b32 v33, s79, v39
    ds_write_b128 v33, v[48:51]
k2_p2ec_r_done:
    v_mfma_f32_32x32x16_bf16 v[176:191], v[2:5], v[64:67], v[176:191]
    ds_read2_b32 v[34:35], v31 offset0:33 offset1:35
    ds_read2_b32 v[36:37], v31 offset0:37 offset1:39
    v_mfma_f32_32x32x16_bf16 v[240:255], v[6:9], v[64:67], v[240:255]
    ds_read_b64_tr_b16 v[40:41], v28 offset:0
    ds_read_b64_tr_b16 v[42:43], v28 offset:64
    ds_read_b64_tr_b16 v[44:45], v28 offset:128
    ds_read_b64_tr_b16 v[46:47], v28 offset:192
    ds_read_u16_d16_hi v38, v30
    v_add_u32 v30, v30, v29
    s_sub_u32 s26, s26, 1
    s_cbranch_scc1 k2_epi2e
k2_p2oc:
    s_waitcnt vmcnt(4)
    ds_read_b64_tr_b16 v[52:53], v18 offset:4096
    ds_read_b64_tr_b16 v[54:55], v18 offset:4352
    ds_read_b64_tr_b16 v[56:57], v19 offset:4096
    ds_read_b64_tr_b16 v[58:59], v19 offset:4352
    ds_read_b64_tr_b16 v[60:61], v20 offset:4096
    ds_read_b64_tr_b16 v[62:63], v20 offset:4352
    ds_read_b64_tr_b16 v[64:65], v21 offset:4096
    ds_read_b64_tr_b16 v[66:67], v21 offset:4352
    s_waitcnt lgkmcnt(8)
    v_mad_u32_u16 v34, v34, s78, v22 op_sel:[1,0,0,0]
    v_mad_u32_u16 v35, v35, s78, v23 op_sel:[1,0,0,0]
    v_mad_u32_u16 v36, v36, s78, v24 op_sel:[1,0,0,0]
    v_mad_u32_u16 v37, v37, s78, v25 op_sel:[1,0,0,0]
    v_mul_f32_dpp v6, v38, v40 row_newbcast:0 row_mask:0xf bank_mask:0xf
    v_mul_f32_dpp v7, v38, v41 row_newbcast:1 row_mask:0xf bank_mask:0xf
    v_cvt_pk_bf16_f32 v2, v6, v7
    v_mul_f32_dpp v8, v38, v42 row_newbcast:2 row_mask:0xf bank_mask:0xf
    v_mul_f32_dpp v9, v38, v43 row_newbcast:3 row_mask:0xf bank_mask:0xf
    v_cvt_pk_bf16_f32 v3, v8, v9
    v_mul_f32_dpp v6, v38, v44 row_newbcast:4 row_mask:0xf bank_mask:0xf
    v_mul_f32_dpp v7, v38, v45 row_newbcast:5 row_mask:0xf bank_mask:0xf
    v_cvt_pk_bf16_f32 v4, v6, v7
    v_mul_f32_dpp v8, v38, v46 row_newbcast:6 row_mask:0xf bank_mask:0xf
    v_mul_f32_dpp v9, v38, v47 row_newbcast:7 row_mask:0xf bank_mask:0xf
    v_cvt_pk_bf16_f32 v5, v8, v9
    s_waitcnt lgkmcnt(6)
    v_mfma_f32_32x32x16_bf16 v[128:143], v[10:13], v[52:55], v[128:143]
    s_add_u32 m0, s67, 4096
    v_mul_f32_dpp v40, v38, v40 row_newbcast:8 row_mask:0xf bank_mask:0xf
    v_mul_f32_dpp v41, v38, v41 row_newbcast:9 row_mask:0xf bank_mask:0xf
    v_cvt_pk_bf16_f32 v6, v40, v41
    v_mfma_f32_32x32x16_bf16 v[192:207], v[14:17], v[52:55], v[192:207]
    s_waitcnt lgkmcnt(0)
    buffer_load_dwordx4 v34, s[4:7], s64 offen offset:0 lds
    v_mul_f32_dpp v42, v38, v42 row_newbcast:10 row_mask:0xf bank_mask:0xf
    v_mul_f32_dpp v43, v38, v43 row_newbcast:11 row_mask:0xf bank_mask:0xf
    v_cvt_pk_bf16_f32 v7, v42, v43
    v_mfma_f32_32x32x16_bf16 v[144:159], v[10:13], v[56:59], v[144:159]
    buffer_load_dwordx4 v35, s[4:7], s64 offen offset:1024 lds
    v_mul_f32_dpp v44, v38, v44 row_newbcast:12 row_mask:0xf bank_mask:0xf
    v_mul_f32_dpp v45, v38, v45 row_newbcast:13 row_mask:0xf bank_mask:0xf
    v_cvt_pk_bf16_f32 v8, v44, v45
    v_mfma_f32_32x32x16_bf16 v[208:223], v[14:17], v[56:59], v[208:223]
    buffer_load_dwordx4 v36, s[4:7], s64 offen offset:2048 lds
    v_mul_f32_dpp v46, v38, v46 row_newbcast:14 row_mask:0xf bank_mask:0xf
    v_mul_f32_dpp v47, v38, v47 row_newbcast:15 row_mask:0xf bank_mask:0xf
    v_cvt_pk_bf16_f32 v9, v46, v47
    v_mfma_f32_32x32x16_bf16 v[160:175], v[10:13], v[60:63], v[160:175]
    buffer_load_dwordx4 v37, s[4:7], s64 offen offset:3072 lds
    s_cmp_eq_u32 s27, 0
    s_cselect_b32 s6, 0, s6
    s_sub_u32 s27, s27, 2
    v_add_u32 v31, 0x100, v31
    v_mfma_f32_32x32x16_bf16 v[224:239], v[14:17], v[60:63], v[224:239]
    ds_read2_b32 v[34:35], v31 offset0:1 offset1:3
    ds_read2_b32 v[36:37], v31 offset0:5 offset1:7
    v_mfma_f32_32x32x16_bf16 v[176:191], v[10:13], v[64:67], v[176:191]
    ds_read_b64_tr_b16 v[40:41], v28 offset:512
    ds_read_b64_tr_b16 v[42:43], v28 offset:576
    ds_read_b64_tr_b16 v[44:45], v28 offset:640
    ds_read_b64_tr_b16 v[46:47], v28 offset:704
    ds_read_u16_d16_hi v38, v30
    v_add_u32 v30, v30, v29
    v_mfma_f32_32x32x16_bf16 v[240:255], v[14:17], v[64:67], v[240:255]
    s_sub_u32 s26, s26, 1
    s_cbranch_scc1 k2_epi2o
    s_branch k2_p2ec
k2_p2ef:
    s_setprio 2
    s_bitcmp1_b32 s34, s72
    s_cbranch_scc0 k2_p2ef_pr
    s_setprio 3
k2_p2ef_pr:
    s_waitcnt vmcnt(4)
    ds_read_b64_tr_b16 v[52:53], v18 offset:0
    ds_read_b64_tr_b16 v[54:55], v18 offset:256
    ds_read_b64_tr_b16 v[56:57], v19 offset:0
    ds_read_b64_tr_b16 v[58:59], v19 offset:256
    ds_read_b64_tr_b16 v[60:61], v20 offset:0
    ds_read_b64_tr_b16 v[62:63], v20 offset:256
    ds_read_b64_tr_b16 v[64:65], v21 offset:0
    ds_read_b64_tr_b16 v[66:67], v21 offset:256
    s_waitcnt lgkmcnt(8)
    v_mad_u32_u16 v34, v34, s78, v22 op_sel:[1,0,0,0]
    v_mad_u32_u16 v35, v35, s78, v23 op_sel:[1,0,0,0]
    v_mad_u32_u16 v36, v36, s78, v24 op_sel:[1,0,0,0]
    v_mad_u32_u16 v37, v37, s78, v25 op_sel:[1,0,0,0]
    v_mul_f32_dpp v14, v38, v40 row_newbcast:0 row_mask:0xf bank_mask:0xf
    v_mul_f32_dpp v15, v38, v41 row_newbcast:1 row_mask:0xf bank_mask:0xf
    v_cvt_pk_bf16_f32 v10, v14, v15
    v_mul_f32_dpp v16, v38, v42 row_newbcast:2 row_mask:0xf bank_mask:0xf
    v_mul_f32_dpp v17, v38, v43 row_newbcast:3 row_mask:0xf bank_mask:0xf
    v_cvt_pk_bf16_f32 v11, v16, v17
    v_mul_f32_dpp v14, v38, v44 row_newbcast:4 row_mask:0xf bank_mask:0xf
    v_mul_f32_dpp v15, v38, v45 row_newbcast:5 row_mask:0xf bank_mask:0xf
    v_cvt_pk_bf16_f32 v12, v14, v15
    v_mul_f32_dpp v16, v38, v46 row_newbcast:6 row_mask:0xf bank_mask:0xf
    v_mul_f32_dpp v17, v38, v47 row_newbcast:7 row_mask:0xf bank_mask:0xf
    v_cvt_pk_bf16_f32 v13, v16, v17
    s_waitcnt lgkmcnt(6)
    v_mfma_f32_32x32x16_bf16 v[128:143], v[2:5], v[52:55], 0
    s_add_u32 m0, s67, 0
    v_mul_f32_dpp v40, v38, v40 row_newbcast:8 row_mask:0xf bank_mask:0xf
    v_mul_f32_dpp v41, v38, v41 row_newbcast:9 row_mask:0xf bank_mask:0xf
    v_cvt_pk_bf16_f32 v14, v40, v41
    v_mfma_f32_32x32x16_bf16 v[192:207], v[6:9], v[52:55], 0
    s_waitcnt lgkmcnt(0)
    buffer_load_dwordx4 v34, s[4:7], s64 offen offset:0 lds
    v_mul_f32_dpp v42, v38, v42 row_newbcast:10 row_mask:0xf bank_mask:0xf
    v_mul_f32_dpp v43, v38, v43 row_newbcast:11 row_mask:0xf bank_mask:0xf
    v_cvt_pk_bf16_f32 v15, v42, v43
    v_mfma_f32_32x32x16_bf16 v[144:159], v[2:5], v[56:59], 0
    buffer_load_dwordx4 v35, s[4:7], s64 offen offset:1024 lds
    v_mul_f32_dpp v44, v38, v44 row_newbcast:12 row_mask:0xf bank_mask:0xf
    v_mul_f32_dpp v45, v38, v45 row_newbcast:13 row_mask:0xf bank_mask:0xf
    v_cvt_pk_bf16_f32 v16, v44, v45
    v_mfma_f32_32x32x16_bf16 v[208:223], v[6:9], v[56:59], 0
    buffer_load_dwordx4 v36, s[4:7], s64 offen offset:2048 lds
    v_mul_f32_dpp v46, v38, v46 row_newbcast:14 row_mask:0xf bank_mask:0xf
    v_mul_f32_dpp v47, v38, v47 row_newbcast:15 row_mask:0xf bank_mask:0xf
    v_cvt_pk_bf16_f32 v17, v46, v47
    v_mfma_f32_32x32x16_bf16 v[160:175], v[2:5], v[60:63], 0
    buffer_load_dwordx4 v37, s[4:7], s64 offen offset:3072 lds
    s_add_u32 s70, s70, 1
    v_mfma_f32_32x32x16_bf16 v[224:239], v[6:9], v[60:63], 0
    s_and_b32 s74, s70, 3
    s_lshl_b32 s74, s74, 10
    s_cmp_lt_u32 s70, s80
    s_cselect_b32 s74, s79, s74
    v_and_or_b32 v28, s74, v27, v26
    s_cbranch_scc0 k2_p2ef_r_done
    s_cmp_ge_u32 s70, s71
    s_cbranch_scc1 k2_p2ef_r_g
    s_lshl_b32 s74, s70, 2
    s_set_gpr_idx_on s74, gpr_idx(SRC0)
    v_mov_b32 v48, v88
    v_mov_b32 v49, v89
    v_mov_b32 v50, v90
    v_mov_b32 v51, v91
    s_set_gpr_idx_off
    v_or_b32 v33, s79, v39
    ds_write_b128 v33, v[48:51]
k2_p2ef_r_done:
    v_mfma_f32_32x32x16_bf16 v[176:191], v[2:5], v[64:67], 0
    ds_read2_b32 v[34:35], v31 offset0:33 offset1:35
    ds_read2_b32 v[36:37], v31 offset0:37 offset1:39
    v_mfma_f32_32x32x16_bf16 v[240:255], v[6:9], v[64:67], 0
    ds_read_b64_tr_b16 v[40:41], v28 offset:0
    ds_read_b64_tr_b16 v[42:43], v28 offset:64
    ds_read_b64_tr_b16 v[44:45], v28 offset:128
    ds_read_b64_tr_b16 v[46:47], v28 offset:192
    ds_read_u16_d16_hi v38, v30
    v_add_u32 v30, v30, v29
    s_sub_u32 s26, s26, 1
    s_cbranch_scc1 k2_epi2e
    s_branch k2_p2oc
k2_p2of:
    s_setprio 2
    s_bitcmp1_b32 s34, s72
    s_cbranch_scc0 k2_p2of_pr
    s_setprio 3
k2_p2of_pr:
    s_waitcnt vmcnt(4)
    ds_read_b64_tr_b16 v[52:53], v18 offset:4096
    ds_read_b64_tr_b16 v[54:55], v18 offset:4352
    ds_read_b64_tr_b16 v[56:57], v19 offset:4096
    ds_read_b64_tr_b16 v[58:59], v19 offset:4352
    ds_read_b64_tr_b16 v[60:61], v20 offset:4096
    ds_read_b64_tr_b16 v[62:63], v20 offset:4352
    ds_read_b64_tr_b16 v[64:65], v21 offset:4096
    ds_read_b64_tr_b16 v[66:67], v21 offset:4352
    s_waitcnt lgkmcnt(8)
    v_mad_u32_u16 v34, v34, s78, v22 op_sel:[1,0,0,0]
    v_mad_u32_u16 v35, v35, s78, v23 op_sel:[1,0,0,0]
    v_mad_u32_u16 v36, v36, s78, v24 op_sel:[1,0,0,0]
    v_mad_u32_u16 v37, v37, s78, v25 op_sel:[1,0,0,0]
    v_mul_f32_dpp v6, v38, v40 row_newbcast:0 row_mask:0xf bank_mask:0xf
    v_mul_f32_dpp v7, v38, v41 row_newbcast:1 row_mask:0xf bank_mask:0xf
    v_cvt_pk_bf16_f32 v2, v6, v7
    v_mul_f32_dpp v8, v38, v42 row_newbcast:2 row_mask:0xf bank_mask:0xf
    v_mul_f32_dpp v9, v38, v43 row_newbcast:3 row_mask:0xf bank_mask:0xf
    v_cvt_pk_bf16_f32 v3, v8, v9
    v_mul_f32_dpp v6, v38, v44 row_newbcast:4 row_mask:0xf bank_mask:0xf
    v_mul_f32_dpp v7, v38, v45 row_newbcast:5 row_mask:0xf bank_mask:0xf
    v_cvt_pk_bf16_f32 v4, v6, v7
    v_mul_f32_dpp v8, v38, v46 row_newbcast:6 row_mask:0xf bank_mask:0xf
    v_mul_f32_dpp v9, v38, v47 row_newbcast:7 row_mask:0xf bank_mask:0xf
    v_cvt_pk_bf16_f32 v5, v8, v9
    s_waitcnt lgkmcnt(6)
    v_mfma_f32_32x32x16_bf16 v[128:143], v[10:13], v[52:55], 0
    s_add_u32 m0, s67, 4096
    v_mul_f32_dpp v40, v38, v40 row_newbcast:8 row_mask:0xf bank_mask:0xf
    v_mul_f32_dpp v41, v38, v41 row_newbcast:9 row_mask:0xf bank_mask:0xf
    v_cvt_pk_bf16_f32 v6, v40, v41
    v_mfma_f32_32x32x16_bf16 v[192:207], v[14:17], v[52:55], 0
    s_waitcnt lgkmcnt(0)
    buffer_load_dwordx4 v34, s[4:7], s64 offen offset:0 lds
    v_mul_f32_dpp v42, v38, v42 row_newbcast:10 row_mask:0xf bank_mask:0xf
    v_mul_f32_dpp v43, v38, v43 row_newbcast:11 row_mask:0xf bank_mask:0xf
    v_cvt_pk_bf16_f32 v7, v42, v43
    v_mfma_f32_32x32x16_bf16 v[144:159], v[10:13], v[56:59], 0
    buffer_load_dwordx4 v35, s[4:7], s64 offen offset:1024 lds
    v_mul_f32_dpp v44, v38, v44 row_newbcast:12 row_mask:0xf bank_mask:0xf
    v_mul_f32_dpp v45, v38, v45 row_newbcast:13 row_mask:0xf bank_mask:0xf
    v_cvt_pk_bf16_f32 v8, v44, v45
    v_mfma_f32_32x32x16_bf16 v[208:223], v[14:17], v[56:59], 0
    buffer_load_dwordx4 v36, s[4:7], s64 offen offset:2048 lds
    v_mul_f32_dpp v46, v38, v46 row_newbcast:14 row_mask:0xf bank_mask:0xf
    v_mul_f32_dpp v47, v38, v47 row_newbcast:15 row_mask:0xf bank_mask:0xf
    v_cvt_pk_bf16_f32 v9, v46, v47
    v_mfma_f32_32x32x16_bf16 v[160:175], v[10:13], v[60:63], 0
    buffer_load_dwordx4 v37, s[4:7], s64 offen offset:3072 lds
    s_cmp_eq_u32 s27, 0
    s_cselect_b32 s6, 0, s6
    s_sub_u32 s27, s27, 2
    v_add_u32 v31, 0x100, v31
    v_mfma_f32_32x32x16_bf16 v[224:239], v[14:17], v[60:63], 0
    ds_read2_b32 v[34:35], v31 offset0:1 offset1:3
    ds_read2_b32 v[36:37], v31 offset0:5 offset1:7
    v_mfma_f32_32x32x16_bf16 v[176:191], v[10:13], v[64:67], 0
    ds_read_b64_tr_b16 v[40:41], v28 offset:512
    ds_read_b64_tr_b16 v[42:43], v28 offset:576
    ds_read_b64_tr_b16 v[44:45], v28 offset:640
    ds_read_b64_tr_b16 v[46:47], v28 offset:704
    ds_read_u16_d16_hi v38, v30
    v_add_u32 v30, v30, v29
    v_mfma_f32_32x32x16_bf16 v[240:255], v[14:17], v[64:67], 0
    s_sub_u32 s26, s26, 1
    s_cbranch_scc1 k2_epi2o
    s_branch k2_p2ec
k2_epi2e:
    s_setprio 0
    ds_read_b128 v[52:55], v0 offset:16384
    ds_read_b128 v[56:59], v0 offset:18432
    ds_read_b128 v[60:63], v0 offset:16896
    ds_read_b128 v[64:67], v0 offset:18944
    ds_read_b128 v[2:5], v0 offset:12288
    ds_read_b128 v[6:9], v0 offset:14336
    s_set_gpr_idx_on s72, gpr_idx(SRC0)
    v_mov_b32 v48, v68
    v_mov_b32 v49, v70
    v_mov_b32 v50, v71
    s_set_gpr_idx_off
    s_nop 3
    s_waitcnt lgkmcnt(4)
    v_pk_mul_f32 v[136:137], v[136:137], v[52:53]
    v_pk_mul_f32 v[200:201], v[200:201], v[52:53] neg_lo:[1,0] neg_hi:[1,0]
    v_pk_mul_f32 v[168:169], v[168:169], v[52:53] neg_lo:[1,0] neg_hi:[1,0]
    v_pk_fma_f32 v[136:137], v[138:139], v[54:55], v[136:137]
    v_pk_fma_f32 v[200:201], v[202:203], v[54:55], v[200:201] neg_lo:[1,0,0] neg_hi:[1,0,0]
    v_pk_fma_f32 v[168:169], v[170:171], v[54:55], v[168:169] neg_lo:[1,0,0] neg_hi:[1,0,0]
    v_pk_fma_f32 v[136:137], v[140:141], v[56:57], v[136:137]
    v_pk_fma_f32 v[200:201], v[204:205], v[56:57], v[200:201] neg_lo:[1,0,0] neg_hi:[1,0,0]
    v_pk_fma_f32 v[168:169], v[172:173], v[56:57], v[168:169] neg_lo:[1,0,0] neg_hi:[1,0,0]
    v_pk_fma_f32 v[136:137], v[142:143], v[58:59], v[136:137]
    v_pk_fma_f32 v[200:201], v[206:207], v[58:59], v[200:201] neg_lo:[1,0,0] neg_hi:[1,0,0]
    v_pk_fma_f32 v[168:169], v[174:175], v[58:59], v[168:169] neg_lo:[1,0,0] neg_hi:[1,0,0]
    v_pk_fma_f32 v[200:201], v[224:225], v[52:53], v[200:201]
    v_pk_fma_f32 v[200:201], v[226:227], v[54:55], v[200:201]
    v_pk_fma_f32 v[200:201], v[228:229], v[56:57], v[200:201]
    v_pk_fma_f32 v[200:201], v[230:231], v[58:59], v[200:201]
    ds_read_b128 v[224:227], v0 offset:12800
    ds_read_b128 v[228:231], v0 offset:14848
    ds_read_b128 v[52:55], v0 offset:4096
    ds_read_b128 v[56:59], v0 offset:6144
    s_waitcnt lgkmcnt(6)
    v_pk_mul_f32 v[138:139], v[152:153], v[60:61]
    v_pk_mul_f32 v[202:203], v[216:217], v[60:61] neg_lo:[1,0] neg_hi:[1,0]
    v_pk_mul_f32 v[170:171], v[184:185], v[60:61] neg_lo:[1,0] neg_hi:[1,0]
    v_pk_fma_f32 v[138:139], v[154:155], v[62:63], v[138:139]
    v_pk_fma_f32 v[202:203], v[218:219], v[62:63], v[202:203] neg_lo:[1,0,0] neg_hi:[1,0,0]
    v_pk_fma_f32 v[170:171], v[186:187], v[62:63], v[170:171] neg_lo:[1,0,0] neg_hi:[1,0,0]
    v_pk_fma_f32 v[138:139], v[156:157], v[64:65], v[138:139]
    v_pk_fma_f32 v[202:203], v[220:221], v[64:65], v[202:203] neg_lo:[1,0,0] neg_hi:[1,0,0]
    v_pk_fma_f32 v[170:171], v[188:189], v[64:65], v[170:171] neg_lo:[1,0,0] neg_hi:[1,0,0]
    v_pk_fma_f32 v[138:139], v[158:159], v[66:67], v[138:139]
    v_pk_fma_f32 v[202:203], v[222:223], v[66:67], v[202:203] neg_lo:[1,0,0] neg_hi:[1,0,0]
    v_pk_fma_f32 v[170:171], v[190:191], v[66:67], v[170:171] neg_lo:[1,0,0] neg_hi:[1,0,0]
    v_pk_fma_f32 v[202:203], v[240:241], v[60:61], v[202:203]
    v_pk_fma_f32 v[202:203], v[242:243], v[62:63], v[202:203]
    v_pk_fma_f32 v[202:203], v[244:245], v[64:65], v[202:203]
    v_pk_fma_f32 v[202:203], v[246:247], v[66:67], v[202:203]
    ds_read_b128 v[152:155], v0 offset:4608
    ds_read_b128 v[156:159], v0 offset:6656
    s_waitcnt lgkmcnt(6)
    v_pk_mul_f32 v[128:129], v[128:129], v[2:3]
    v_pk_mul_f32 v[160:161], v[160:161], v[2:3]
    v_pk_fma_f32 v[128:129], v[130:131], v[4:5], v[128:129]
    v_pk_fma_f32 v[160:161], v[162:163], v[4:5], v[160:161]
    v_pk_fma_f32 v[128:129], v[132:133], v[6:7], v[128:129]
    v_pk_fma_f32 v[160:161], v[164:165], v[6:7], v[160:161]
    v_pk_fma_f32 v[128:129], v[134:135], v[8:9], v[128:129]
    v_pk_fma_f32 v[160:161], v[166:167], v[8:9], v[160:161]
    s_waitcnt lgkmcnt(4)
    v_pk_mul_f32 v[130:131], v[144:145], v[224:225]
    v_pk_mul_f32 v[162:163], v[176:177], v[224:225]
    v_pk_fma_f32 v[130:131], v[146:147], v[226:227], v[130:131]
    v_pk_fma_f32 v[162:163], v[178:179], v[226:227], v[162:163]
    v_pk_fma_f32 v[130:131], v[148:149], v[228:229], v[130:131]
    v_pk_fma_f32 v[162:163], v[180:181], v[228:229], v[162:163]
    v_pk_fma_f32 v[130:131], v[150:151], v[230:231], v[130:131]
    v_pk_fma_f32 v[162:163], v[182:183], v[230:231], v[162:163]
    s_waitcnt lgkmcnt(2)
    v_pk_mul_f32 v[192:193], v[192:193], v[52:53]
    v_pk_fma_f32 v[192:193], v[194:195], v[54:55], v[192:193]
    v_pk_fma_f32 v[192:193], v[196:197], v[56:57], v[192:193]
    v_pk_fma_f32 v[192:193], v[198:199], v[58:59], v[192:193]
    v_pk_fma_f32 v[192:193], v[232:233], v[52:53], v[192:193]
    v_pk_fma_f32 v[192:193], v[234:235], v[54:55], v[192:193]
    v_pk_fma_f32 v[192:193], v[236:237], v[56:57], v[192:193]
    v_pk_fma_f32 v[192:193], v[238:239], v[58:59], v[192:193]
    s_waitcnt lgkmcnt(0)
    v_pk_mul_f32 v[194:195], v[208:209], v[152:153]
    v_pk_fma_f32 v[194:195], v[210:211], v[154:155], v[194:195]
    v_pk_fma_f32 v[194:195], v[212:213], v[156:157], v[194:195]
    v_pk_fma_f32 v[194:195], v[214:215], v[158:159], v[194:195]
    v_pk_fma_f32 v[194:195], v[248:249], v[152:153], v[194:195]
    v_pk_fma_f32 v[194:195], v[250:251], v[154:155], v[194:195]
    v_pk_fma_f32 v[194:195], v[252:253], v[156:157], v[194:195]
    v_pk_fma_f32 v[194:195], v[254:255], v[158:159], v[194:195]
    v_add_f32 v136, v136, v137
    v_add_f32 v138, v138, v139
    v_add_f32 v200, v200, v201
    v_add_f32 v202, v202, v203
    v_add_f32 v168, v168, v169
    v_add_f32 v170, v170, v171
    v_add_f32 v128, v128, v129
    v_add_f32 v130, v130, v131
    v_add_f32 v160, v160, v161
    v_add_f32 v162, v162, v163
    v_add_f32 v192, v192, v193
    v_add_f32 v194, v194, v195
    v_permlane32_swap_b32 v136, v138
    v_permlane32_swap_b32 v200, v202
    v_permlane32_swap_b32 v168, v170
    v_permlane32_swap_b32 v128, v130
    v_permlane32_swap_b32 v160, v162
    v_permlane32_swap_b32 v192, v194
    v_add_f32 v136, v136, v138
    v_add_f32 v200, v200, v202
    v_add_f32 v168, v168, v170
    v_add_f32 v128, v128, v130
    v_add_f32 v160, v160, v162
    v_add_f32 v192, v192, v194
    v_and_b32 v56, s83, v48
    v_and_b32 v57, s83, v49
    v_and_b32 v58, s83, v50
    v_add_f32 v192, v192, v56
    v_add_f32 v168, v168, v57
    v_add_f32 v136, v136, v58
    v_lshlrev_b32 v48, 16, v48
    v_lshlrev_b32 v49, 16, v49
    v_lshlrev_b32 v50, 16, v50
    s_set_gpr_idx_on s72, gpr_idx(DST)
    v_cvt_pk_bf16_f32 v68, v48, v192
    v_cvt_pk_bf16_f32 v70, v49, v128
    v_cvt_pk_bf16_f32 v71, v50, v160
    s_set_gpr_idx_off
    s_set_gpr_idx_on s73, gpr_idx(DST)
    v_cvt_pk_bf16_f32 v88, v200, v168
    v_cvt_pk_bf16_f32 v89, v136, v136
    s_set_gpr_idx_off
    s_add_u32 s72, s72, 4
    s_add_u32 s73, s73, 2
    s_lshr_b64 s[30:31], s[30:31], 12
    s_and_b32 s26, s30, 0xfff
    s_branch k2_p2of
k2_epi2o:
    s_setprio 0
    ds_read_b128 v[52:55], v0 offset:16384
    ds_read_b128 v[56:59], v0 offset:18432
    ds_read_b128 v[60:63], v0 offset:16896
    ds_read_b128 v[64:67], v0 offset:18944
    ds_read_b128 v[10:13], v0 offset:12288
    ds_read_b128 v[14:17], v0 offset:14336
    s_set_gpr_idx_on s72, gpr_idx(SRC0)
    v_mov_b32 v48, v68
    v_mov_b32 v49, v70
    v_mov_b32 v50, v71
    s_set_gpr_idx_off
    s_nop 3
    s_waitcnt lgkmcnt(4)
    v_pk_mul_f32 v[136:137], v[136:137], v[52:53]
    v_pk_mul_f32 v[200:201], v[200:201], v[52:53] neg_lo:[1,0] neg_hi:[1,0]
    v_pk_mul_f32 v[168:169], v[168:169], v[52:53] neg_lo:[1,0] neg_hi:[1,0]
    v_pk_fma_f32 v[136:137], v[138:139], v[54:55], v[136:137]
    v_pk_fma_f32 v[200:201], v[202:203], v[54:55], v[200:201] neg_lo:[1,0,0] neg_hi:[1,0,0]
    v_pk_fma_f32 v[168:169], v[170:171], v[54:55], v[168:169] neg_lo:[1,0,0] neg_hi:[1,0,0]
    v_pk_fma_f32 v[136:137], v[140:141], v[56:57], v[136:137]
    v_pk_fma_f32 v[200:201], v[204:205], v[56:57], v[200:201] neg_lo:[1,0,0] neg_hi:[1,0,0]
    v_pk_fma_f32 v[168:169], v[172:173], v[56:57], v[168:169] neg_lo:[1,0,0] neg_hi:[1,0,0]
    v_pk_fma_f32 v[136:137], v[142:143], v[58:59], v[136:137]
    v_pk_fma_f32 v[200:201], v[206:207], v[58:59], v[200:201] neg_lo:[1,0,0] neg_hi:[1,0,0]
    v_pk_fma_f32 v[168:169], v[174:175], v[58:59], v[168:169] neg_lo:[1,0,0] neg_hi:[1,0,0]
    v_pk_fma_f32 v[200:201], v[224:225], v[52:53], v[200:201]
    v_pk_fma_f32 v[200:201], v[226:227], v[54:55], v[200:201]
    v_pk_fma_f32 v[200:201], v[228:229], v[56:57], v[200:201]
    v_pk_fma_f32 v[200:201], v[230:231], v[58:59], v[200:201]
    ds_read_b128 v[224:227], v0 offset:12800
    ds_read_b128 v[228:231], v0 offset:14848
    ds_read_b128 v[52:55], v0 offset:4096
    ds_read_b128 v[56:59], v0 offset:6144
    s_waitcnt lgkmcnt(6)
    v_pk_mul_f32 v[138:139], v[152:153], v[60:61]
    v_pk_mul_f32 v[202:203], v[216:217], v[60:61] neg_lo:[1,0] neg_hi:[1,0]
    v_pk_mul_f32 v[170:171], v[184:185], v[60:61] neg_lo:[1,0] neg_hi:[1,0]
    v_pk_fma_f32 v[138:139], v[154:155], v[62:63], v[138:139]
    v_pk_fma_f32 v[202:203], v[218:219], v[62:63], v[202:203] neg_lo:[1,0,0] neg_hi:[1,0,0]
    v_pk_fma_f32 v[170:171], v[186:187], v[62:63], v[170:171] neg_lo:[1,0,0] neg_hi:[1,0,0]
    v_pk_fma_f32 v[138:139], v[156:157], v[64:65], v[138:139]
    v_pk_fma_f32 v[202:203], v[220:221], v[64:65], v[202:203] neg_lo:[1,0,0] neg_hi:[1,0,0]
    v_pk_fma_f32 v[170:171], v[188:189], v[64:65], v[170:171] neg_lo:[1,0,0] neg_hi:[1,0,0]
    v_pk_fma_f32 v[138:139], v[158:159], v[66:67], v[138:139]
    v_pk_fma_f32 v[202:203], v[222:223], v[66:67], v[202:203] neg_lo:[1,0,0] neg_hi:[1,0,0]
    v_pk_fma_f32 v[170:171], v[190:191], v[66:67], v[170:171] neg_lo:[1,0,0] neg_hi:[1,0,0]
    v_pk_fma_f32 v[202:203], v[240:241], v[60:61], v[202:203]
    v_pk_fma_f32 v[202:203], v[242:243], v[62:63], v[202:203]
    v_pk_fma_f32 v[202:203], v[244:245], v[64:65], v[202:203]
    v_pk_fma_f32 v[202:203], v[246:247], v[66:67], v[202:203]
    ds_read_b128 v[152:155], v0 offset:4608
    ds_read_b128 v[156:159], v0 offset:6656
    s_waitcnt lgkmcnt(6)
    v_pk_mul_f32 v[128:129], v[128:129], v[10:11]
    v_pk_mul_f32 v[160:161], v[160:161], v[10:11]
    v_pk_fma_f32 v[128:129], v[130:131], v[12:13], v[128:129]
    v_pk_fma_f32 v[160:161], v[162:163], v[12:13], v[160:161]
    v_pk_fma_f32 v[128:129], v[132:133], v[14:15], v[128:129]
    v_pk_fma_f32 v[160:161], v[164:165], v[14:15], v[160:161]
    v_pk_fma_f32 v[128:129], v[134:135], v[16:17], v[128:129]
    v_pk_fma_f32 v[160:161], v[166:167], v[16:17], v[160:161]
    s_waitcnt lgkmcnt(4)
    v_pk_mul_f32 v[130:131], v[144:145], v[224:225]
    v_pk_mul_f32 v[162:163], v[176:177], v[224:225]
    v_pk_fma_f32 v[130:131], v[146:147], v[226:227], v[130:131]
    v_pk_fma_f32 v[162:163], v[178:179], v[226:227], v[162:163]
    v_pk_fma_f32 v[130:131], v[148:149], v[228:229], v[130:131]
    v_pk_fma_f32 v[162:163], v[180:181], v[228:229], v[162:163]
    v_pk_fma_f32 v[130:131], v[150:151], v[230:231], v[130:131]
    v_pk_fma_f32 v[162:163], v[182:183], v[230:231], v[162:163]
    s_waitcnt lgkmcnt(2)
    v_pk_mul_f32 v[192:193], v[192:193], v[52:53]
    v_pk_fma_f32 v[192:193], v[194:195], v[54:55], v[192:193]
    v_pk_fma_f32 v[192:193], v[196:197], v[56:57], v[192:193]
    v_pk_fma_f32 v[192:193], v[198:199], v[58:59], v[192:193]
    v_pk_fma_f32 v[192:193], v[232:233], v[52:53], v[192:193]
    v_pk_fma_f32 v[192:193], v[234:235], v[54:55], v[192:193]
    v_pk_fma_f32 v[192:193], v[236:237], v[56:57], v[192:193]
    v_pk_fma_f32 v[192:193], v[238:239], v[58:59], v[192:193]
    s_waitcnt lgkmcnt(0)
    v_pk_mul_f32 v[194:195], v[208:209], v[152:153]
    v_pk_fma_f32 v[194:195], v[210:211], v[154:155], v[194:195]
    v_pk_fma_f32 v[194:195], v[212:213], v[156:157], v[194:195]
    v_pk_fma_f32 v[194:195], v[214:215], v[158:159], v[194:195]
    v_pk_fma_f32 v[194:195], v[248:249], v[152:153], v[194:195]
    v_pk_fma_f32 v[194:195], v[250:251], v[154:155], v[194:195]
    v_pk_fma_f32 v[194:195], v[252:253], v[156:157], v[194:195]
    v_pk_fma_f32 v[194:195], v[254:255], v[158:159], v[194:195]
    v_add_f32 v136, v136, v137
    v_add_f32 v138, v138, v139
    v_add_f32 v200, v200, v201
    v_add_f32 v202, v202, v203
    v_add_f32 v168, v168, v169
    v_add_f32 v170, v170, v171
    v_add_f32 v128, v128, v129
    v_add_f32 v130, v130, v131
    v_add_f32 v160, v160, v161
    v_add_f32 v162, v162, v163
    v_add_f32 v192, v192, v193
    v_add_f32 v194, v194, v195
    v_permlane32_swap_b32 v136, v138
    v_permlane32_swap_b32 v200, v202
    v_permlane32_swap_b32 v168, v170
    v_permlane32_swap_b32 v128, v130
    v_permlane32_swap_b32 v160, v162
    v_permlane32_swap_b32 v192, v194
    v_add_f32 v136, v136, v138
    v_add_f32 v200, v200, v202
    v_add_f32 v168, v168, v170
    v_add_f32 v128, v128, v130
    v_add_f32 v160, v160, v162
    v_add_f32 v192, v192, v194
    v_and_b32 v56, s83, v48
    v_and_b32 v57, s83, v49
    v_and_b32 v58, s83, v50
    v_add_f32 v192, v192, v56
    v_add_f32 v168, v168, v57
    v_add_f32 v136, v136, v58
    v_lshlrev_b32 v48, 16, v48
    v_lshlrev_b32 v49, 16, v49
    v_lshlrev_b32 v50, 16, v50
    s_set_gpr_idx_on s72, gpr_idx(DST)
    v_cvt_pk_bf16_f32 v68, v48, v192
    v_cvt_pk_bf16_f32 v70, v49, v128
    v_cvt_pk_bf16_f32 v71, v50, v160
    s_set_gpr_idx_off
    s_set_gpr_idx_on s73, gpr_idx(DST)
    v_cvt_pk_bf16_f32 v88, v200, v168
    v_cvt_pk_bf16_f32 v89, v136, v136
    s_set_gpr_idx_off
    s_add_u32 s72, s72, 4
    s_add_u32 s73, s73, 2
    s_lshr_b64 s[30:31], s[30:31], 12
    s_and_b32 s26, s30, 0xfff
    s_cmp_eq_u32 s72, s84
    s_cbranch_scc1 k2_p2_end
    s_branch k2_p2ef
k2_p2_end:
    s_and_b32 s74, s3, 3
    s_lshl_b32 s74, s74, 10
    s_add_u32 s74, s74, 8781824
    v_lshlrev_b32 v48, 4, v1
    v_add_u32 v48, s74, v48
    s_waitcnt vmcnt(0)
    s_movk_i32 s75, 0
    buffer_load_dwordx4 v[128:131], v48, s[12:15], s75 offen
    s_movk_i32 s75, 4096
    buffer_load_dwordx4 v[132:135], v48, s[12:15], s75 offen
    s_movk_i32 s75, 8192
    buffer_load_dwordx4 v[136:139], v48, s[12:15], s75 offen
    s_movk_i32 s75, 12288
    buffer_load_dwordx4 v[140:143], v48, s[12:15], s75 offen
    s_movk_i32 s75, 16384
    buffer_load_dwordx4 v[144:147], v48, s[12:15], s75 offen
    s_movk_i32 s75, 20480
    buffer_load_dwordx4 v[148:151], v48, s[12:15], s75 offen
    s_movk_i32 s75, 24576
    buffer_load_dwordx4 v[152:155], v48, s[12:15], s75 offen
    s_movk_i32 s75, 28672
    buffer_load_dwordx4 v[156:159], v48, s[12:15], s75 offen
    s_mov_b32 s75, 32768
    buffer_load_dwordx4 v[160:163], v48, s[12:15], s75 offen
    s_mov_b32 s75, 36864
    buffer_load_dwordx4 v[164:167], v48, s[12:15], s75 offen
    v_lshl_add_u32 v49, v1, 2, s67
    v_lshl_add_u32 v50, v1, 1, s67
    ds_write_b32 v49, v68 offset:0
    ds_write_b32 v49, v69 offset:256
    ds_write_b32 v49, v70 offset:640
    ds_write_b32 v49, v71 offset:1024
    ds_write_b16 v50, v88 offset:512
    ds_write_b16_d16_hi v50, v88 offset:896
    ds_write_b16 v50, v89 offset:1280
    ds_write_b32 v49, v72 offset:1424
    ds_write_b32 v49, v73 offset:1680
    ds_write_b32 v49, v74 offset:2064
    ds_write_b32 v49, v75 offset:2448
    ds_write_b16 v50, v90 offset:1936
    ds_write_b16_d16_hi v50, v90 offset:2320
    ds_write_b16 v50, v91 offset:2704
    ds_write_b32 v49, v76 offset:2848
    ds_write_b32 v49, v77 offset:3104
    ds_write_b32 v49, v78 offset:3488
    ds_write_b32 v49, v79 offset:3872
    ds_write_b16 v50, v92 offset:3360
    ds_write_b16_d16_hi v50, v92 offset:3744
    ds_write_b16 v50, v93 offset:4128
    ds_write_b32 v49, v80 offset:4272
    ds_write_b32 v49, v81 offset:4528
    ds_write_b32 v49, v82 offset:4912
    ds_write_b32 v49, v83 offset:5296
    ds_write_b16 v50, v94 offset:4784
    ds_write_b16_d16_hi v50, v94 offset:5168
    ds_write_b16 v50, v95 offset:5552
    ds_write_b32 v49, v84 offset:5696
    ds_write_b32 v49, v85 offset:5952
    ds_write_b32 v49, v86 offset:6336
    ds_write_b32 v49, v87 offset:6720
    ds_write_b16 v50, v96 offset:6208
    ds_write_b16_d16_hi v50, v96 offset:6592
    ds_write_b16 v50, v97 offset:6976
    s_lshr_b32 s84, s3, 2
    s_lshl_b32 s74, s84, 4
    s_lshl_b32 s75, s84, 1
    v_and_b32 v52, 15, v1
    v_and_b32 v53, 7, v1
    v_bfe_u32 v59, v1, 3, 1
    v_add_u32 v52, s74, v52
    v_add_u32 v53, 32, v53
    v_add_u32 v59, s75, v59
    v_mul_u32_u24 v54, 52, v52
    v_mul_u32_u24 v55, 52, v53
    v_lshrrev_b32 v54, 8, v54
    v_lshrrev_b32 v55, 8, v55
    v_mad_i32_i24 v56, v54, -5, v52
    v_mad_i32_i24 v57, v55, -5, v53
    v_lshl_add_u32 v52, v54, 3, v56
    v_lshl_add_u32 v53, v55, 3, v57
    v_mov_b32 v58, 163584
    v_lshl_add_u32 v52, v52, 1, v58
    v_lshl_add_u32 v53, v53, 1, v58
    ds_read_u16 v52, v52
    ds_read_u16 v53, v53
    v_mul_u32_u24 v56, 1424, v56
    v_mul_u32_u24 v57, 1424, v57
    v_lshl_add_u32 v56, v54, 13, v56
    v_lshl_add_u32 v57, v55, 13, v57
    v_lshrrev_b32 v54, 4, v1
    v_min_u32 v58, 2, v59
    v_lshl_add_u32 v56, v54, 4, v56
    v_lshl_add_u32 v57, v54, 4, v57
    v_mul_u32_u24 v58, 384, v58
    v_cmp_eq_u32 s[32:33], 3, v59
    v_add_u32 v59, 1, v59
    v_add_u32 v58, v57, v58
    v_and_b32 v59, 3, v59
    s_mul_i32 s74, s2, 20480
    s_and_b32 s75, s3, 3
    s_lshl_b32 s75, s75, 5
    s_add_u32 s74, s74, s75
    v_lshl_add_u32 v54, v54, 3, s74
    v_lshl_add_u32 v55, v59, 7, v54
    s_waitcnt lgkmcnt(0)
    s_barrier
    ds_read_b128 v[168:171], v56 offset:0
    ds_read_b128 v[172:175], v56 offset:64
    ds_read_b128 v[176:179], v56 offset:128
    ds_read_b128 v[180:183], v56 offset:192
    ds_read_b128 v[184:187], v56 offset:256
    ds_read_b128 v[188:191], v56 offset:320
    ds_read_b128 v[192:195], v56 offset:384
    ds_read_b128 v[196:199], v56 offset:448
    ds_read_b128 v[200:203], v56 offset:512
    ds_read_b128 v[204:207], v56 offset:576
    ds_read_b128 v[60:63], v57 offset:0
    ds_read_b128 v[64:67], v57 offset:64
    ds_read_b128 v[68:71], v57 offset:128
    ds_read_b128 v[72:75], v57 offset:192
    ds_read_b128 v[76:79], v58 offset:256
    v_lshl_add_u32 v52, v52, 9, v54
    v_lshl_add_u32 v53, v53, 9, v55
    v_lshrrev_b32 v54, 4, v1
    v_and_b32 v59, 15, v1
    v_lshlrev_b32 v54, 2, v54
    v_lshl_add_u32 v59, v59, 4, v54
    s_waitcnt vmcnt(0) lgkmcnt(5)
    v_mfma_f32_16x16x32_bf16 v[2:5], v[128:131], v[168:171], 0
    ds_read_b128 v[80:83], v58 offset:320
    v_mfma_f32_16x16x32_bf16 v[6:9], v[144:147], v[184:187], 0
    ds_read_b128 v[84:87], v58 offset:384
    v_mfma_f32_16x16x32_bf16 v[2:5], v[132:135], v[172:175], v[2:5]
    ds_read_b128 v[88:91], v58 offset:448
    v_mfma_f32_16x16x32_bf16 v[6:9], v[148:151], v[188:191], v[6:9]
    ds_read_b128 v[92:95], v58 offset:512
    v_mfma_f32_16x16x32_bf16 v[2:5], v[136:139], v[176:179], v[2:5]
    ds_read_b128 v[96:99], v58 offset:576
    v_mfma_f32_16x16x32_bf16 v[6:9], v[152:155], v[192:195], v[6:9]
    ds_read_b128 v[208:211], v56 offset:640
    v_mfma_f32_16x16x32_bf16 v[2:5], v[140:143], v[180:183], v[2:5]
    ds_read_b128 v[212:215], v56 offset:704
    v_mfma_f32_16x16x32_bf16 v[6:9], v[156:159], v[196:199], v[6:9]
    ds_read_b128 v[216:219], v56 offset:768
    v_mfma_f32_16x16x32_bf16 v[6:9], v[160:163], v[200:203], v[6:9]
    ds_read_b128 v[220:223], v56 offset:832
    v_mfma_f32_16x16x32_bf16 v[6:9], v[164:167], v[204:207], v[6:9]
    ds_read_b128 v[224:227], v56 offset:896
    s_waitcnt lgkmcnt(5)
    v_mfma_f32_16x16x32_bf16 v[100:103], v[128:131], v[60:63], 0
    ds_read_b128 v[228:231], v56 offset:960
    v_mul_f32 v108, 0xbfb8aa3b, v2
    v_mul_f32 v109, 0xbfb8aa3b, v3
    v_mfma_f32_16x16x32_bf16 v[104:107], v[144:147], v[76:79], 0
    ds_read_b128 v[232:235], v56 offset:1024
    v_mul_f32 v110, 0xbfb8aa3b, v4
    v_mul_f32 v111, 0xbfb8aa3b, v5
    v_mfma_f32_16x16x32_bf16 v[100:103], v[132:135], v[64:67], v[100:103]
    ds_read_b128 v[236:239], v56 offset:1088
    v_exp_f32 v108, v108
    v_exp_f32 v109, v109
    v_mfma_f32_16x16x32_bf16 v[104:107], v[148:151], v[80:83], v[104:107]
    ds_read_b128 v[240:243], v56 offset:1152
    v_exp_f32 v110, v110
    v_exp_f32 v111, v111
    v_mfma_f32_16x16x32_bf16 v[100:103], v[136:139], v[68:71], v[100:103]
    ds_read_b128 v[244:247], v56 offset:1216
    v_add_f32 v108, 1.0, v108
    v_add_f32 v109, 1.0, v109
    v_mfma_f32_16x16x32_bf16 v[104:107], v[152:155], v[84:87], v[104:107]
    ds_read_b128 v[248:251], v56 offset:1280
    v_add_f32 v110, 1.0, v110
    v_add_f32 v111, 1.0, v111
    v_mfma_f32_16x16x32_bf16 v[100:103], v[140:143], v[72:75], v[100:103]
    ds_read_b128 v[252:255], v56 offset:1344
    v_rcp_f32 v108, v108
    v_rcp_f32 v109, v109
    v_mfma_f32_16x16x32_bf16 v[104:107], v[156:159], v[88:91], v[104:107]
    v_rcp_f32 v110, v110
    v_rcp_f32 v111, v111
    v_mfma_f32_16x16x32_bf16 v[104:107], v[160:163], v[92:95], v[104:107]
    v_mfma_f32_16x16x32_bf16 v[104:107], v[164:167], v[96:99], v[104:107]
    ds_permute_b32 v52, v59, v52
    ds_permute_b32 v53, v59, v53
    s_waitcnt lgkmcnt(0)
    v_mfma_f32_16x16x32_bf16 v[10:13], v[144:147], v[208:211], 0
    v_cvt_pk_bf16_f32 v116, v2, v3
    v_cvt_pk_bf16_f32 v117, v4, v5
    ds_permute_b32 v116, v59, v116
    ds_permute_b32 v117, v59, v117
    v_mfma_f32_16x16x32_bf16 v[14:17], v[144:147], v[232:235], 0
    v_mul_f32 v60, v6, v108
    v_mul_f32 v61, v7, v109
    v_mul_f32 v62, v8, v110
    v_mul_f32 v63, v9, v111
    v_mfma_f32_16x16x32_bf16 v[10:13], v[148:151], v[212:215], v[10:13]
    v_cvt_pk_bf16_f32 v118, v60, v61
    v_cvt_pk_bf16_f32 v119, v62, v63
    ds_permute_b32 v118, v59, v118
    ds_permute_b32 v119, v59, v119
    v_mfma_f32_16x16x32_bf16 v[14:17], v[148:151], v[236:239], v[14:17]
    v_mul_f32 v112, 0xbfb8aa3b, v100
    v_mul_f32 v113, 0xbfb8aa3b, v101
    v_mul_f32 v114, 0xbfb8aa3b, v102
    v_mul_f32 v115, 0xbfb8aa3b, v103
    v_mfma_f32_16x16x32_bf16 v[10:13], v[152:155], v[216:219], v[10:13]
    v_exp_f32 v112, v112
    v_exp_f32 v113, v113
    v_exp_f32 v114, v114
    v_exp_f32 v115, v115
    v_mfma_f32_16x16x32_bf16 v[14:17], v[152:155], v[240:243], v[14:17]
    v_add_f32 v112, 1.0, v112
    v_add_f32 v113, 1.0, v113
    v_add_f32 v114, 1.0, v114
    v_add_f32 v115, 1.0, v115
    v_mfma_f32_16x16x32_bf16 v[10:13], v[156:159], v[220:223], v[10:13]
    v_rcp_f32 v112, v112
    v_rcp_f32 v113, v113
    v_rcp_f32 v114, v114
    v_rcp_f32 v115, v115
    v_mfma_f32_16x16x32_bf16 v[14:17], v[156:159], v[244:247], v[14:17]
    v_mul_f32 v64, v104, v112
    v_mul_f32 v65, v105, v113
    v_mul_f32 v66, v106, v114
    v_mul_f32 v67, v107, v115
    v_mfma_f32_16x16x32_bf16 v[10:13], v[160:163], v[224:227], v[10:13]
    v_cndmask_b32 v64, v64, v100, s[32:33]
    v_cndmask_b32 v65, v65, v101, s[32:33]
    v_cndmask_b32 v66, v66, v102, s[32:33]
    v_cndmask_b32 v67, v67, v103, s[32:33]
    v_mfma_f32_16x16x32_bf16 v[14:17], v[160:163], v[248:251], v[14:17]
    v_cvt_pk_bf16_f32 v124, v64, v65
    v_cvt_pk_bf16_f32 v125, v66, v67
    ds_permute_b32 v124, v59, v124
    ds_permute_b32 v125, v59, v125
    v_mfma_f32_16x16x32_bf16 v[10:13], v[164:167], v[228:231], v[10:13]
    v_mfma_f32_16x16x32_bf16 v[14:17], v[164:167], v[252:255], v[14:17]
    s_cmp_lg_u32 s22, 0
    s_cbranch_scc1 k2_fbacc
k2_store:
    s_waitcnt lgkmcnt(4)
    buffer_store_dwordx2 v[116:117], v52, s[16:19], 0 offen offset:0
    s_waitcnt lgkmcnt(2)
    buffer_store_dwordx2 v[118:119], v52, s[16:19], 0 offen offset:128
    s_nop 3
    v_mul_f32 v10, v10, v108
    v_mul_f32 v11, v11, v109
    v_mul_f32 v12, v12, v110
    v_mul_f32 v13, v13, v111
    v_cvt_pk_bf16_f32 v120, v10, v11
    v_cvt_pk_bf16_f32 v121, v12, v13
    ds_permute_b32 v120, v59, v120
    ds_permute_b32 v121, v59, v121
    v_mul_f32 v14, v14, v108
    v_mul_f32 v15, v15, v109
    v_mul_f32 v16, v16, v110
    v_mul_f32 v17, v17, v111
    v_cvt_pk_bf16_f32 v122, v14, v15
    v_cvt_pk_bf16_f32 v123, v16, v17
    ds_permute_b32 v122, v59, v122
    ds_permute_b32 v123, v59, v123
    s_waitcnt lgkmcnt(4)
    buffer_store_dwordx2 v[124:125], v53, s[16:19], 0 offen offset:0
    s_waitcnt lgkmcnt(2)
    buffer_store_dwordx2 v[120:121], v52, s[16:19], 0 offen offset:256
    s_waitcnt lgkmcnt(0)
    buffer_store_dwordx2 v[122:123], v52, s[16:19], 0 offen offset:384
k2_next:
    s_cmp_eq_u32 s22, 0
    s_cbranch_scc1 k2_end
    s_cmp_eq_u32 s23, 0
    s_cbranch_scc1 k2_end
    s_add_u32 s20, s20, s21
    s_mov_b32 s82, 0
    s_and_b32 s74, s2, 7
    s_lshl_b32 s74, s74, 5
    s_lshr_b32 s75, s2, 3
    s_add_u32 s74, s74, s75
    s_lshl_b32 s74, s74, 2
    s_add_u32 s74, s74, 8388608
    s_lshl_b32 s75, s3, 15
    s_add_u32 s74, s74, s75
    s_lshl_b32 s75, s3, 6
    v_add_u32 v0, s75, v1
    v_and_b32 v48, 31, v0
    v_lshlrev_b32 v48, 10, v48
    v_add_u32 v48, s74, v48
    buffer_load_dword v126, v48, s[12:15], 0 offen
    s_waitcnt lgkmcnt(0)
    s_barrier
    s_branch k2_round
k2_end:
    s_endpgm
k2_p2_r0_g:
    s_lshl_b32 s74, s70, 7
    v_add_u32 v33, s74, v32
    ds_read_b32 v33, v33
    s_add_u32 m0, s68, s79
    s_waitcnt lgkmcnt(0)
    v_and_or_b32 v33, v22, 16, v33
    buffer_load_dwordx4 v33, s[8:11], 0 offen  lds
    s_waitcnt vmcnt(0)
    s_branch k2_p2_r0_done
k2_p2ec_r_g:
    s_lshl_b32 s74, s70, 7
    v_add_u32 v33, s74, v32
    ds_read_b32 v33, v33
    s_add_u32 m0, s68, s79
    s_waitcnt lgkmcnt(0)
    v_and_or_b32 v33, v22, 16, v33
    buffer_load_dwordx4 v33, s[8:11], 0 offen  lds
    s_waitcnt vmcnt(0)
    s_branch k2_p2ec_r_done
k2_p2ef_r_g:
    s_lshl_b32 s74, s70, 7
    v_add_u32 v33, s74, v32
    ds_read_b32 v33, v33
    s_add_u32 m0, s68, s79
    s_waitcnt lgkmcnt(0)
    v_and_or_b32 v33, v22, 16, v33
    buffer_load_dwordx4 v33, s[8:11], 0 offen  lds
    s_waitcnt vmcnt(0)
    s_branch k2_p2ef_r_done
k2_fbacc:
    s_nop 7
    s_lshl_b32 s74, s2, 3
    s_add_u32 s74, s74, s3
    s_lshl_b32 s74, s74, 13
    s_add_u32 s74, s74, 9437184
    v_lshlrev_b32 v54, 4, v1
    v_add_u32 v54, s74, v54
    v_add_u32 v55, 0x1000, v54
    s_cmp_lg_u32 s82, 0
    s_cbranch_scc1 k2_noacc
    buffer_load_dwordx4 v[168:171], v54, s[12:15], 0 offen offset:0 sc0 sc1
    buffer_load_dwordx4 v[172:175], v54, s[12:15], 0 offen offset:1024 sc0 sc1
    buffer_load_dwordx4 v[176:179], v54, s[12:15], 0 offen offset:2048 sc0 sc1
    buffer_load_dwordx4 v[180:183], v54, s[12:15], 0 offen offset:3072 sc0 sc1
    buffer_load_dwordx4 v[184:187], v55, s[12:15], 0 offen offset:0 sc0 sc1
    buffer_load_dwordx4 v[188:191], v55, s[12:15], 0 offen offset:1024 sc0 sc1
    s_waitcnt vmcnt(0)
    v_add_f32 v2, v2, v168
    v_add_f32 v3, v3, v169
    v_add_f32 v4, v4, v170
    v_add_f32 v5, v5, v171
    v_add_f32 v6, v6, v172
    v_add_f32 v7, v7, v173
    v_add_f32 v8, v8, v174
    v_add_f32 v9, v9, v175
    v_add_f32 v10, v10, v176
    v_add_f32 v11, v11, v177
    v_add_f32 v12, v12, v178
    v_add_f32 v13, v13, v179
    v_add_f32 v14, v14, v180
    v_add_f32 v15, v15, v181
    v_add_f32 v16, v16, v182
    v_add_f32 v17, v17, v183
    v_add_f32 v100, v100, v184
    v_add_f32 v101, v101, v185
    v_add_f32 v102, v102, v186
    v_add_f32 v103, v103, v187
    v_add_f32 v104, v104, v188
    v_add_f32 v105, v105, v189
    v_add_f32 v106, v106, v190
    v_add_f32 v107, v107, v191
    s_waitcnt lgkmcnt(0)
    v_mul_f32 v108, 0xbfb8aa3b, v2
    v_mul_f32 v109, 0xbfb8aa3b, v3
    v_mul_f32 v110, 0xbfb8aa3b, v4
    v_mul_f32 v111, 0xbfb8aa3b, v5
    v_exp_f32 v108, v108
    v_exp_f32 v109, v109
    v_exp_f32 v110, v110
    v_exp_f32 v111, v111
    v_add_f32 v108, 1.0, v108
    v_add_f32 v109, 1.0, v109
    v_add_f32 v110, 1.0, v110
    v_add_f32 v111, 1.0, v111
    v_rcp_f32 v108, v108
    v_rcp_f32 v109, v109
    v_rcp_f32 v110, v110
    v_rcp_f32 v111, v111
    v_cvt_pk_bf16_f32 v116, v2, v3
    v_cvt_pk_bf16_f32 v117, v4, v5
    ds_permute_b32 v116, v59, v116
    ds_permute_b32 v117, v59, v117
    v_mul_f32 v60, v6, v108
    v_mul_f32 v61, v7, v109
    v_mul_f32 v62, v8, v110
    v_mul_f32 v63, v9, v111
    v_cvt_pk_bf16_f32 v118, v60, v61
    v_cvt_pk_bf16_f32 v119, v62, v63
    ds_permute_b32 v118, v59, v118
    ds_permute_b32 v119, v59, v119
    v_mul_f32 v112, 0xbfb8aa3b, v100
    v_mul_f32 v113, 0xbfb8aa3b, v101
    v_mul_f32 v114, 0xbfb8aa3b, v102
    v_mul_f32 v115, 0xbfb8aa3b, v103
    v_exp_f32 v112, v112
    v_exp_f32 v113, v113
    v_exp_f32 v114, v114
    v_exp_f32 v115, v115
    v_add_f32 v112, 1.0, v112
    v_add_f32 v113, 1.0, v113
    v_add_f32 v114, 1.0, v114
    v_add_f32 v115, 1.0, v115
    v_rcp_f32 v112, v112
    v_rcp_f32 v113, v113
    v_rcp_f32 v114, v114
    v_rcp_f32 v115, v115
    v_mul_f32 v64, v104, v112
    v_mul_f32 v65, v105, v113
    v_mul_f32 v66, v106, v114
    v_mul_f32 v67, v107, v115
    v_cndmask_b32 v64, v64, v100, s[32:33]
    v_cndmask_b32 v65, v65, v101, s[32:33]
    v_cndmask_b32 v66, v66, v102, s[32:33]
    v_cndmask_b32 v67, v67, v103, s[32:33]
    v_cvt_pk_bf16_f32 v124, v64, v65
    v_cvt_pk_bf16_f32 v125, v66, v67
    ds_permute_b32 v124, v59, v124
    ds_permute_b32 v125, v59, v125
k2_noacc:
    s_cmp_eq_u32 s23, 0
    s_cbranch_scc1 k2_store
    buffer_store_dwordx4 v[2:5], v54, s[12:15], 0 offen offset:0 sc0 sc1
    buffer_store_dwordx4 v[6:9], v54, s[12:15], 0 offen offset:1024 sc0 sc1
    buffer_store_dwordx4 v[10:13], v54, s[12:15], 0 offen offset:2048 sc0 sc1
    buffer_store_dwordx4 v[14:17], v54, s[12:15], 0 offen offset:3072 sc0 sc1
    buffer_store_dwordx4 v[100:103], v55, s[12:15], 0 offen offset:0 sc0 sc1
    buffer_store_dwordx4 v[104:107], v55, s[12:15], 0 offen offset:1024 sc0 sc1
    s_waitcnt vmcnt(0)
    s_branch k2_next
.section .rodata,"a"
.p2align 6
.amdhsa_kernel k1_kernel
  .amdhsa_next_free_vgpr 56
  .amdhsa_next_free_sgpr 102
  .amdhsa_accum_offset 56
  .amdhsa_group_segment_fixed_size 0
  .amdhsa_kernarg_size 96
  .amdhsa_user_sgpr_count 2
  .amdhsa_user_sgpr_kernarg_segment_ptr 1
  .amdhsa_system_sgpr_workgroup_id_x 1
.end_amdhsa_kernel
.section .rodata,"a"
.p2align 6
.amdhsa_kernel k2_kernel
  .amdhsa_next_free_vgpr 256
  .amdhsa_next_free_sgpr 102
  .amdhsa_accum_offset 256
  .amdhsa_group_segment_fixed_size 0
  .amdhsa_kernarg_size 96
  .amdhsa_user_sgpr_count 2
  .amdhsa_user_sgpr_kernarg_segment_ptr 1
  .amdhsa_system_sgpr_workgroup_id_x 1
.end_amdhsa_kernel
```
